```python
import torch

def _softmax(x, axis=-1):
    return torch.softmax(x, dim=axis)
def _gelu(x):
    return torch.nn.functional.gelu(x, approximate="tanh")
def _silu(x):
    return torch.nn.functional.silu(x)
def _sigmoid(x):
    return torch.sigmoid(x)
def _layernorm(x, axis=-1, eps=1e-5):
    m = x.mean(dim=axis, keepdim=True)
    v = x.var(dim=axis, keepdim=True, unbiased=False)
    return (x - m) / torch.sqrt(v + eps)
def _scatter_add(tgt, idx, src, axis=0):
    return tgt.clone().index_add_(axis, idx, src)
def _segment_sum(src, seg, n):
    out = torch.zeros((n,) + src.shape[1:], dtype=src.dtype)
    return out.index_add_(0, seg, src)
def _pad(x, pw):
    flat = tuple(v for pair in reversed(pw) for v in pair)
    return torch.nn.functional.pad(x, flat)

kernel_name = 'parallel_sum__mha_block_cached__dense_activation_silu__decode'

def setup_inputs():

    _w = (lambda a: (lambda t: t.to(torch.bfloat16) if t.is_floating_point() else t)(torch.as_tensor(a)))
    def _A_setup():
        B, Sq, D = 8, 1, 512
        H, Sk, Dh = 32, 4096, 128
        return {
            "x": _w((lambda *s: torch.randn(*s, dtype=torch.bfloat16) * 0.05)(B, Sq, D)),
            "k_cache": _w((lambda *s: torch.randn(*s, dtype=torch.bfloat16) * 3.2)(B, H, Sk, Dh)),
            "v_cache": _w((lambda *s: torch.randn(*s, dtype=torch.bfloat16) * 0.8)(B, H, Sk, Dh)),
            "wq": _w((lambda *s: torch.randn(*s, dtype=torch.bfloat16) * 3.2)(D, H * Dh) * (D ** -0.5)),
            "wo": _w((lambda *s: torch.randn(*s, dtype=torch.bfloat16) * 0.8)(H * Dh, D) * ((H * Dh) ** -0.5)),
        }
    _A_in = _A_setup()

    def _B_setup():
        B, S, D, F = 8, 1, 512, 1792
        return {
            "x": _w((lambda *s: torch.randn(*s, dtype=torch.bfloat16) * 0.05)(B, S, D)),
            "w1": _w((lambda *s: torch.randn(*s, dtype=torch.bfloat16) * 3.2)(D, F) * (D ** -0.5)),
            "w2": _w((lambda *s: torch.randn(*s, dtype=torch.bfloat16) * 0.4)(F, D) * (F ** -0.5)),
        }
    _B_in = _B_setup()

    return {
        "A_x": _A_in["x"],
        "A_k_cache": _A_in["k_cache"],
        "A_v_cache": _A_in["v_cache"],
        "A_wq": _A_in["wq"],
        "A_wo": _A_in["wo"],
        "B_x": _B_in["x"],
        "B_w1": _B_in["w1"],
        "B_w2": _B_in["w2"],
    }

def reference(A_x, A_k_cache, A_v_cache, A_wq, A_wo, B_x, B_w1, B_w2):
    def _A_ref(x, k_cache, v_cache, wq, wo):
        B, Sq, D = x.shape
        H, Dh = 32, 128
        q = (lambda x, *d: x.permute(*d))((x @ wq).reshape(B, Sq, H, Dh), 0, 2, 1, 3)
        scores = torch.einsum("bhqd,bhkd->bhqk", q, k_cache) * (Dh ** -0.5)
        p = _softmax(scores, axis=-1)
        o = torch.einsum("bhqk,bhkd->bhqd", p, v_cache)
        return (lambda x, *d: x.permute(*d))(o, 0, 2, 1, 3).reshape(B, Sq, H * Dh) @ wo

    def _B_ref(x, w1, w2):
        h = torch.einsum("bsd,df->bsf", x, w1)
        h = _silu(h)
        out = torch.einsum("bsf,fd->bsd", h, w2)
        return out

    x = A_x
    xn = _layernorm(x, axis=-1)
    return x + _A_ref(xn, A_k_cache, A_v_cache, A_wq, A_wo) + _B_ref(xn, B_w1, B_w2)
```

```asm
; @launch grid=(256,1,1) block=(576,1,1) lds=8704
.amdgcn_target "amdgcn-amd-amdhsa--gfx950"
.text
.globl parallel_sum__mha_block_cached__dense_activation_silu__decode_kernel
.p2align 8
.type parallel_sum__mha_block_cached__dense_activation_silu__decode_kernel,@function
parallel_sum__mha_block_cached__dense_activation_silu__decode_kernel:
    s_load_dwordx16 s[4:19], s[0:1], 0
    s_cmp_ge_u32 s2, 256
    s_cbranch_scc1 L_end
    v_lshrrev_b32 v1, 6, v0
    v_and_b32 v0, 63, v0
    v_readfirstlane_b32 s3, v1
    s_lshr_b32 s26, s2, 5
    s_and_b32 s27, s2, 31
    s_mov_b32 s31, 0x20000
    s_cmp_lt_u32 s3, 4
    s_cbranch_scc1 L_stream
    s_cmp_eq_u32 s3, 8
    s_cbranch_scc1 L_ctrl
    s_sub_u32 s3, s3, 4
    s_brev_b32 s52, s26
    s_lshr_b32 s52, s52, 27
    s_xor_b32 s52, s52, s27
    v_lshrrev_b32 v3, 4, v0
    v_and_b32 v2, 15, v0
    s_lshl_b32 s38, s26, 10
    v_lshl_add_u32 v6, v0, 4, s38
    s_lshl_b32 s39, s26, 1
    v_add_u32 v7, s39, v2
    v_and_b32 v7, 15, v7
    v_lshl_add_u32 v7, v3, 4, v7
    s_lshl_b32 s39, s3, 8
    s_add_u32 s38, s38, s39
    v_lshl_add_u32 v35, v7, 2, s38
    s_lshl_b32 s39, s3, 2
    v_add_u32 v32, s39, v3
    v_lshlrev_b32 v1, 18, v32
    v_lshl_add_u32 v1, v2, 4, v1
    s_lshl_b32 s38, s27, 8
    s_sub_u32 s30, 0x400000, s38
    s_lshl_b32 s36, s26, 15
    s_waitcnt lgkmcnt(0)
    s_add_u32 s28, s10, s38
    s_addc_u32 s29, s11, 0
    global_load_dwordx4 v[24:27], v6, s[4:5]
    global_load_dword v5, v35, s[4:5]
    buffer_load_dwordx4 v[40:43], v1, s[28:31], s36 offen
    s_add_u32 s36, s36, 0x2000
    buffer_load_dwordx4 v[44:47], v1, s[28:31], s36 offen
    s_add_u32 s36, s36, 0x2000
    buffer_load_dwordx4 v[48:51], v1, s[28:31], s36 offen
    s_add_u32 s36, s36, 0x2000
    buffer_load_dwordx4 v[52:55], v1, s[28:31], s36 offen
    s_add_u32 s36, s36, 0x2000
    s_and_b32 s36, s36, 0x3ffff
    s_load_dwordx4 s[20:23], s[0:1], 64
    s_load_dwordx2 s[24:25], s[0:1], 80
    s_waitcnt lgkmcnt(0)
    s_and_b32 s38, s27, 3
    s_lshl_b32 s39, s38, 2
    s_add_u32 s39, s39, s3
    s_lshl_b32 s39, s39, 7
    s_lshl_b32 s47, s26, 16
    s_add_u32 s39, s39, s47
    s_add_u32 s32, s24, s39
    s_addc_u32 s33, s25, 0
    s_mov_b32 s34, 0x10000
    s_mov_b32 s35, 0x20000
    v_lshrrev_b32 v38, 3, v0
    v_lshlrev_b32 v38, 11, v38
    v_and_b32 v36, 7, v0
    v_lshl_add_u32 v38, v36, 4, v38
    v_lshrrev_b32 v28, 1, v3
    v_lshl_add_u32 v36, v36, 1, v28
    v_and_b32 v28, 1, v3
    v_lshl_add_u32 v36, v36, 3, v28
    s_lshl_b32 s38, s38, 7
    s_lshl_b32 s47, s26, 9
    s_add_u32 s38, s38, s47
    s_lshl_b32 s47, s3, 1
    s_add_u32 s38, s38, s47
    v_add_lshl_u32 v36, v36, s38, 1
    s_mov_b32 s45, 0x4000
    s_mov_b32 s46, 0x8000
    s_mov_b32 s57, 0xc000
    s_cmp_ge_u32 s52, 4
    s_cbranch_scc1 L_noclr
    v_mov_b32 v28, -1
    v_mov_b32 v29, -1
    v_mov_b32 v30, -1
    v_mov_b32 v31, -1
    buffer_store_dwordx4 v[28:31], v38, s[32:35], 0 offen sc1
    buffer_store_dwordx4 v[28:31], v38, s[32:35], s45 offen sc1
    buffer_store_dwordx4 v[28:31], v38, s[32:35], s46 offen sc1
    buffer_store_dwordx4 v[28:31], v38, s[32:35], s57 offen sc1
    s_or_b32 s38, s52, s3
    s_cbranch_scc1 L_noclr
    s_mul_i32 s38, s26, 4352
    s_add_u32 s38, s38, 524288
    v_lshl_add_u32 v33, v0, 2, s38
    v_mov_b32 v34, 0
    global_store_dword v33, v34, s[24:25] sc1
    v_add_u32 v33, 0x10000, v33
    global_store_dword v33, v34, s[24:25] sc1
L_noclr:
    s_mov_b32 s37, 0
    s_mov_b32 s40, 0x05040100
    s_mov_b32 s41, 0x07060302
    s_mov_b32 s44, 0xffff0000
    s_waitcnt vmcnt(4)
    v_lshlrev_b32 v16, 16, v24
    v_and_b32 v17, s44, v24
    v_lshlrev_b32 v18, 16, v25
    v_and_b32 v19, s44, v25
    v_lshlrev_b32 v20, 16, v26
    v_and_b32 v21, s44, v26
    v_lshlrev_b32 v22, 16, v27
    v_and_b32 v23, s44, v27
    v_add_f32 v33, v16, v17
    v_add_f32 v33, v33, v18
    v_add_f32 v33, v33, v19
    v_add_f32 v33, v33, v20
    v_add_f32 v33, v33, v21
    v_add_f32 v33, v33, v22
    v_add_f32 v33, v33, v23
    s_nop 1
    v_add_f32_dpp v33, v33, v33 row_ror:8 row_mask:0xf bank_mask:0xf
    s_nop 1
    v_add_f32_dpp v33, v33, v33 row_ror:4 row_mask:0xf bank_mask:0xf
    s_nop 1
    v_add_f32_dpp v33, v33, v33 row_ror:2 row_mask:0xf bank_mask:0xf
    s_nop 1
    v_add_f32_dpp v33, v33, v33 row_ror:1 row_mask:0xf bank_mask:0xf
    v_mov_b32 v35, v33
    s_nop 1
    v_permlane16_swap_b32 v35, v33
    v_add_f32 v33, v33, v35
    v_mov_b32 v35, v33
    s_nop 1
    v_permlane32_swap_b32 v35, v33
    v_add_f32 v33, v33, v35
    v_mul_f32 v33, 0x3b000000, v33
    v_sub_f32 v16, v16, v33
    v_sub_f32 v17, v17, v33
    v_sub_f32 v18, v18, v33
    v_sub_f32 v19, v19, v33
    v_sub_f32 v20, v20, v33
    v_sub_f32 v21, v21, v33
    v_sub_f32 v22, v22, v33
    v_sub_f32 v23, v23, v33
    v_mul_f32 v34, v16, v16
    v_fmac_f32 v34, v17, v17
    v_fmac_f32 v34, v18, v18
    v_fmac_f32 v34, v19, v19
    v_fmac_f32 v34, v20, v20
    v_fmac_f32 v34, v21, v21
    v_fmac_f32 v34, v22, v22
    v_fmac_f32 v34, v23, v23
    s_nop 1
    v_add_f32_dpp v34, v34, v34 row_ror:8 row_mask:0xf bank_mask:0xf
    s_nop 1
    v_add_f32_dpp v34, v34, v34 row_ror:4 row_mask:0xf bank_mask:0xf
    s_nop 1
    v_add_f32_dpp v34, v34, v34 row_ror:2 row_mask:0xf bank_mask:0xf
    s_nop 1
    v_add_f32_dpp v34, v34, v34 row_ror:1 row_mask:0xf bank_mask:0xf
    v_mov_b32 v35, v34
    s_nop 1
    v_permlane16_swap_b32 v35, v34
    v_add_f32 v34, v34, v35
    v_mov_b32 v35, v34
    s_nop 1
    v_permlane32_swap_b32 v35, v34
    v_add_f32 v34, v34, v35
    v_mul_f32 v34, 0x3b000000, v34
    v_cvt_pk_bf16_f32 v33, v33, v34
    v_and_b32 v34, s44, v33
    v_lshlrev_b32 v33, 16, v33
    v_add_f32 v34, 0x3727c5ac, v34
    v_cvt_pk_bf16_f32 v34, v34, v34
    v_and_b32 v34, s44, v34
    v_sqrt_f32 v34, v34
    s_nop 0
    v_cvt_pk_bf16_f32 v34, v34, v34
    v_and_b32 v34, s44, v34
    v_rcp_f32 v34, v34
    v_lshlrev_b32 v16, 16, v5
    v_and_b32 v17, s44, v5
    v_sub_f32 v16, v16, v33
    v_sub_f32 v17, v17, v33
    v_cvt_pk_bf16_f32 v16, v16, v17
    v_and_b32 v17, s44, v16
    v_lshlrev_b32 v16, 16, v16
    v_mul_f32 v16, v16, v34
    v_mul_f32 v17, v17, v34
    v_cvt_pk_bf16_f32 v4, v16, v17
    v_lshlrev_b32 v6, 5, v2
    v_lshl_add_u32 v6, v3, 3, v6
    s_lshl_b32 s38, s3, 9
    v_add_u32 v6, s38, v6
    v_lshlrev_b32 v7, 3, v7
    v_mov_b32 v8, 0
    v_mov_b32 v9, 0
    v_mov_b32 v10, 0
    v_mov_b32 v11, 0
    v_mov_b32 v12, 0
    v_mov_b32 v13, 0
    v_mov_b32 v14, 0
    v_mov_b32 v15, 0
    s_barrier
    buffer_load_dwordx4 v[56:59], v1, s[28:31], s36 offen
    s_add_u32 s36, s36, 0x2000
    buffer_load_dwordx4 v[60:63], v1, s[28:31], s36 offen
    s_add_u32 s36, s36, 0x2000
    buffer_load_dwordx4 v[64:67], v1, s[28:31], s36 offen
    s_add_u32 s36, s36, 0x2000
    buffer_load_dwordx4 v[68:71], v1, s[28:31], s36 offen
    s_add_u32 s36, s36, 0x2000
    s_and_b32 s36, s36, 0x3ffff
    buffer_load_dwordx4 v[72:75], v1, s[28:31], s36 offen
    s_add_u32 s36, s36, 0x2000
    buffer_load_dwordx4 v[76:79], v1, s[28:31], s36 offen
    s_add_u32 s36, s36, 0x2000
    buffer_load_dwordx4 v[80:83], v1, s[28:31], s36 offen
    s_add_u32 s36, s36, 0x2000
    buffer_load_dwordx4 v[84:87], v1, s[28:31], s36 offen
    s_add_u32 s36, s36, 0x2000
    s_and_b32 s36, s36, 0x3ffff
    buffer_load_dwordx4 v[88:91], v1, s[28:31], s36 offen
    s_add_u32 s36, s36, 0x2000
    buffer_load_dwordx4 v[92:95], v1, s[28:31], s36 offen
    s_add_u32 s36, s36, 0x2000
    buffer_load_dwordx4 v[96:99], v1, s[28:31], s36 offen
    s_add_u32 s36, s36, 0x2000
    buffer_load_dwordx4 v[100:103], v1, s[28:31], s36 offen
    s_add_u32 s36, s36, 0x2000
    s_and_b32 s36, s36, 0x3ffff
    buffer_load_dwordx4 v[104:107], v1, s[28:31], s36 offen
    s_add_u32 s36, s36, 0x2000
    buffer_load_dwordx4 v[108:111], v1, s[28:31], s36 offen
    s_add_u32 s36, s36, 0x2000
    buffer_load_dwordx4 v[112:115], v1, s[28:31], s36 offen
    s_add_u32 s36, s36, 0x2000
    buffer_load_dwordx4 v[116:119], v1, s[28:31], s36 offen
    s_add_u32 s36, s36, 0x2000
    s_and_b32 s36, s36, 0x3ffff
    buffer_load_dwordx4 v[120:123], v1, s[28:31], s36 offen
    s_add_u32 s36, s36, 0x2000
    buffer_load_dwordx4 v[124:127], v1, s[28:31], s36 offen
    s_add_u32 s36, s36, 0x2000
    buffer_load_dwordx4 v[128:131], v1, s[28:31], s36 offen
    s_add_u32 s36, s36, 0x2000
    buffer_load_dwordx4 v[132:135], v1, s[28:31], s36 offen
    s_add_u32 s36, s36, 0x2000
    s_and_b32 s36, s36, 0x3ffff
    buffer_load_dwordx4 v[136:139], v1, s[28:31], s36 offen
    s_add_u32 s36, s36, 0x2000
    buffer_load_dwordx4 v[140:143], v1, s[28:31], s36 offen
    s_add_u32 s36, s36, 0x2000
    buffer_load_dwordx4 v[144:147], v1, s[28:31], s36 offen
    s_add_u32 s36, s36, 0x2000
    buffer_load_dwordx4 v[148:151], v1, s[28:31], s36 offen
    s_add_u32 s36, s36, 0x2000
    s_and_b32 s36, s36, 0x3ffff
    buffer_load_dwordx4 v[152:155], v1, s[28:31], s36 offen
    s_add_u32 s36, s36, 0x2000
    buffer_load_dwordx4 v[156:159], v1, s[28:31], s36 offen
    s_add_u32 s36, s36, 0x2000
    buffer_load_dwordx4 v[160:163], v1, s[28:31], s36 offen
    s_add_u32 s36, s36, 0x2000
    buffer_load_dwordx4 v[164:167], v1, s[28:31], s36 offen
    s_barrier
L_perm:
    s_waitcnt vmcnt(30)
    v_perm_b32 v39, v44, v40, s40
    v_perm_b32 v44, v44, v40, s41
    v_perm_b32 v40, v45, v41, s40
    v_perm_b32 v45, v45, v41, s41
    v_perm_b32 v41, v46, v42, s40
    v_perm_b32 v46, v46, v42, s41
    v_perm_b32 v42, v47, v43, s40
    v_perm_b32 v47, v47, v43, s41
    s_waitcnt vmcnt(28)
    v_perm_b32 v43, v52, v48, s40
    v_perm_b32 v52, v52, v48, s41
    v_perm_b32 v48, v53, v49, s40
    v_perm_b32 v53, v53, v49, s41
    v_perm_b32 v49, v54, v50, s40
    v_perm_b32 v54, v54, v50, s41
    v_perm_b32 v50, v55, v51, s40
    v_perm_b32 v55, v55, v51, s41
    s_waitcnt vmcnt(26)
    v_perm_b32 v51, v60, v56, s40
    v_perm_b32 v60, v60, v56, s41
    v_perm_b32 v56, v61, v57, s40
    v_perm_b32 v61, v61, v57, s41
    v_perm_b32 v57, v62, v58, s40
    v_perm_b32 v62, v62, v58, s41
    v_perm_b32 v58, v63, v59, s40
    v_perm_b32 v63, v63, v59, s41
    s_waitcnt vmcnt(24)
    v_perm_b32 v59, v68, v64, s40
    v_perm_b32 v68, v68, v64, s41
    v_perm_b32 v64, v69, v65, s40
    v_perm_b32 v69, v69, v65, s41
    v_perm_b32 v65, v70, v66, s40
    v_perm_b32 v70, v70, v66, s41
    v_perm_b32 v66, v71, v67, s40
    v_perm_b32 v71, v71, v67, s41
    s_waitcnt vmcnt(22)
    v_perm_b32 v67, v76, v72, s40
    v_perm_b32 v76, v76, v72, s41
    v_perm_b32 v72, v77, v73, s40
    v_perm_b32 v77, v77, v73, s41
    v_perm_b32 v73, v78, v74, s40
    v_perm_b32 v78, v78, v74, s41
    v_perm_b32 v74, v79, v75, s40
    v_perm_b32 v79, v79, v75, s41
    s_waitcnt vmcnt(20)
    v_perm_b32 v75, v84, v80, s40
    v_perm_b32 v84, v84, v80, s41
    v_perm_b32 v80, v85, v81, s40
    v_perm_b32 v85, v85, v81, s41
    v_perm_b32 v81, v86, v82, s40
    v_perm_b32 v86, v86, v82, s41
    v_perm_b32 v82, v87, v83, s40
    v_perm_b32 v87, v87, v83, s41
    s_waitcnt vmcnt(18)
    v_perm_b32 v83, v92, v88, s40
    v_perm_b32 v92, v92, v88, s41
    v_perm_b32 v88, v93, v89, s40
    v_perm_b32 v93, v93, v89, s41
    v_perm_b32 v89, v94, v90, s40
    v_perm_b32 v94, v94, v90, s41
    v_perm_b32 v90, v95, v91, s40
    v_perm_b32 v95, v95, v91, s41
    s_waitcnt vmcnt(16)
    v_perm_b32 v91, v100, v96, s40
    v_perm_b32 v100, v100, v96, s41
    v_perm_b32 v96, v101, v97, s40
    v_perm_b32 v101, v101, v97, s41
    v_perm_b32 v97, v102, v98, s40
    v_perm_b32 v102, v102, v98, s41
    v_perm_b32 v98, v103, v99, s40
    v_perm_b32 v103, v103, v99, s41
    s_waitcnt vmcnt(14)
    v_perm_b32 v99, v108, v104, s40
    v_perm_b32 v108, v108, v104, s41
    v_perm_b32 v104, v109, v105, s40
    v_perm_b32 v109, v109, v105, s41
    v_perm_b32 v105, v110, v106, s40
    v_perm_b32 v110, v110, v106, s41
    v_perm_b32 v106, v111, v107, s40
    v_perm_b32 v111, v111, v107, s41
    s_waitcnt vmcnt(12)
    v_perm_b32 v107, v116, v112, s40
    v_perm_b32 v116, v116, v112, s41
    v_perm_b32 v112, v117, v113, s40
    v_perm_b32 v117, v117, v113, s41
    v_perm_b32 v113, v118, v114, s40
    v_perm_b32 v118, v118, v114, s41
    v_perm_b32 v114, v119, v115, s40
    v_perm_b32 v119, v119, v115, s41
    s_waitcnt vmcnt(10)
    v_perm_b32 v115, v124, v120, s40
    v_perm_b32 v124, v124, v120, s41
    v_perm_b32 v120, v125, v121, s40
    v_perm_b32 v125, v125, v121, s41
    v_perm_b32 v121, v126, v122, s40
    v_perm_b32 v126, v126, v122, s41
    v_perm_b32 v122, v127, v123, s40
    v_perm_b32 v127, v127, v123, s41
    s_waitcnt vmcnt(8)
    v_perm_b32 v123, v132, v128, s40
    v_perm_b32 v132, v132, v128, s41
    v_perm_b32 v128, v133, v129, s40
    v_perm_b32 v133, v133, v129, s41
    v_perm_b32 v129, v134, v130, s40
    v_perm_b32 v134, v134, v130, s41
    v_perm_b32 v130, v135, v131, s40
    v_perm_b32 v135, v135, v131, s41
    s_waitcnt vmcnt(6)
    v_perm_b32 v131, v140, v136, s40
    v_perm_b32 v140, v140, v136, s41
    v_perm_b32 v136, v141, v137, s40
    v_perm_b32 v141, v141, v137, s41
    v_perm_b32 v137, v142, v138, s40
    v_perm_b32 v142, v142, v138, s41
    v_perm_b32 v138, v143, v139, s40
    v_perm_b32 v143, v143, v139, s41
    s_waitcnt vmcnt(4)
    v_perm_b32 v139, v148, v144, s40
    v_perm_b32 v148, v148, v144, s41
    v_perm_b32 v144, v149, v145, s40
    v_perm_b32 v149, v149, v145, s41
    v_perm_b32 v145, v150, v146, s40
    v_perm_b32 v150, v150, v146, s41
    v_perm_b32 v146, v151, v147, s40
    v_perm_b32 v151, v151, v147, s41
    s_waitcnt vmcnt(2)
    v_perm_b32 v147, v156, v152, s40
    v_perm_b32 v156, v156, v152, s41
    v_perm_b32 v152, v157, v153, s40
    v_perm_b32 v157, v157, v153, s41
    v_perm_b32 v153, v158, v154, s40
    v_perm_b32 v158, v158, v154, s41
    v_perm_b32 v154, v159, v155, s40
    v_perm_b32 v159, v159, v155, s41
    s_waitcnt vmcnt(0)
    v_perm_b32 v155, v164, v160, s40
    v_perm_b32 v164, v164, v160, s41
    v_perm_b32 v160, v165, v161, s40
    v_perm_b32 v165, v165, v161, s41
    v_perm_b32 v161, v166, v162, s40
    v_perm_b32 v166, v166, v162, s41
    v_perm_b32 v162, v167, v163, s40
    v_perm_b32 v167, v167, v163, s41
    s_cmp_lt_u32 s37, 2
    s_cbranch_scc1 L_dots
    s_barrier
    ds_read2st64_b64 v[16:19], v7 offset0:4 offset1:5
    ds_read2st64_b64 v[20:23], v7 offset0:6 offset1:7
    s_waitcnt lgkmcnt(1)
    v_pk_add_f32 v[16:17], v[16:17], v[18:19]
    s_waitcnt lgkmcnt(0)
    v_pk_add_f32 v[20:21], v[20:21], v[22:23]
    v_pk_add_f32 v[16:17], v[16:17], v[20:21]
    v_cvt_pk_bf16_f32 v4, v16, v17
    s_cmp_eq_u32 s37, 2
    s_cbranch_scc1 L_silu
    .p2align 3
L_dots:
    v_dot2c_f32_bf16_dpp v8, v4, v39 row_newbcast:0 row_mask:0xf bank_mask:0xf
    v_dot2c_f32_bf16_dpp v9, v4, v44 row_newbcast:0 row_mask:0xf bank_mask:0xf
    v_dot2c_f32_bf16_dpp v10, v4, v40 row_newbcast:0 row_mask:0xf bank_mask:0xf
    v_dot2c_f32_bf16_dpp v11, v4, v45 row_newbcast:0 row_mask:0xf bank_mask:0xf
    v_dot2c_f32_bf16_dpp v12, v4, v41 row_newbcast:0 row_mask:0xf bank_mask:0xf
    v_dot2c_f32_bf16_dpp v13, v4, v46 row_newbcast:0 row_mask:0xf bank_mask:0xf
    v_dot2c_f32_bf16_dpp v14, v4, v42 row_newbcast:0 row_mask:0xf bank_mask:0xf
    v_dot2c_f32_bf16_dpp v15, v4, v47 row_newbcast:0 row_mask:0xf bank_mask:0xf
    v_dot2c_f32_bf16_dpp v8, v4, v43 row_newbcast:1 row_mask:0xf bank_mask:0xf
    v_dot2c_f32_bf16_dpp v9, v4, v52 row_newbcast:1 row_mask:0xf bank_mask:0xf
    v_dot2c_f32_bf16_dpp v10, v4, v48 row_newbcast:1 row_mask:0xf bank_mask:0xf
    v_dot2c_f32_bf16_dpp v11, v4, v53 row_newbcast:1 row_mask:0xf bank_mask:0xf
    v_dot2c_f32_bf16_dpp v12, v4, v49 row_newbcast:1 row_mask:0xf bank_mask:0xf
    v_dot2c_f32_bf16_dpp v13, v4, v54 row_newbcast:1 row_mask:0xf bank_mask:0xf
    v_dot2c_f32_bf16_dpp v14, v4, v50 row_newbcast:1 row_mask:0xf bank_mask:0xf
    v_dot2c_f32_bf16_dpp v15, v4, v55 row_newbcast:1 row_mask:0xf bank_mask:0xf
    v_dot2c_f32_bf16_dpp v8, v4, v51 row_newbcast:2 row_mask:0xf bank_mask:0xf
    v_dot2c_f32_bf16_dpp v9, v4, v60 row_newbcast:2 row_mask:0xf bank_mask:0xf
    v_dot2c_f32_bf16_dpp v10, v4, v56 row_newbcast:2 row_mask:0xf bank_mask:0xf
    v_dot2c_f32_bf16_dpp v11, v4, v61 row_newbcast:2 row_mask:0xf bank_mask:0xf
    v_dot2c_f32_bf16_dpp v12, v4, v57 row_newbcast:2 row_mask:0xf bank_mask:0xf
    v_dot2c_f32_bf16_dpp v13, v4, v62 row_newbcast:2 row_mask:0xf bank_mask:0xf
    v_dot2c_f32_bf16_dpp v14, v4, v58 row_newbcast:2 row_mask:0xf bank_mask:0xf
    v_dot2c_f32_bf16_dpp v15, v4, v63 row_newbcast:2 row_mask:0xf bank_mask:0xf
    v_dot2c_f32_bf16_dpp v8, v4, v59 row_newbcast:3 row_mask:0xf bank_mask:0xf
    v_dot2c_f32_bf16_dpp v9, v4, v68 row_newbcast:3 row_mask:0xf bank_mask:0xf
    v_dot2c_f32_bf16_dpp v10, v4, v64 row_newbcast:3 row_mask:0xf bank_mask:0xf
    v_dot2c_f32_bf16_dpp v11, v4, v69 row_newbcast:3 row_mask:0xf bank_mask:0xf
    v_dot2c_f32_bf16_dpp v12, v4, v65 row_newbcast:3 row_mask:0xf bank_mask:0xf
    v_dot2c_f32_bf16_dpp v13, v4, v70 row_newbcast:3 row_mask:0xf bank_mask:0xf
    v_dot2c_f32_bf16_dpp v14, v4, v66 row_newbcast:3 row_mask:0xf bank_mask:0xf
    v_dot2c_f32_bf16_dpp v15, v4, v71 row_newbcast:3 row_mask:0xf bank_mask:0xf
    v_dot2c_f32_bf16_dpp v8, v4, v67 row_newbcast:4 row_mask:0xf bank_mask:0xf
    v_dot2c_f32_bf16_dpp v9, v4, v76 row_newbcast:4 row_mask:0xf bank_mask:0xf
    v_dot2c_f32_bf16_dpp v10, v4, v72 row_newbcast:4 row_mask:0xf bank_mask:0xf
    v_dot2c_f32_bf16_dpp v11, v4, v77 row_newbcast:4 row_mask:0xf bank_mask:0xf
    v_dot2c_f32_bf16_dpp v12, v4, v73 row_newbcast:4 row_mask:0xf bank_mask:0xf
    v_dot2c_f32_bf16_dpp v13, v4, v78 row_newbcast:4 row_mask:0xf bank_mask:0xf
    v_dot2c_f32_bf16_dpp v14, v4, v74 row_newbcast:4 row_mask:0xf bank_mask:0xf
    v_dot2c_f32_bf16_dpp v15, v4, v79 row_newbcast:4 row_mask:0xf bank_mask:0xf
    v_dot2c_f32_bf16_dpp v8, v4, v75 row_newbcast:5 row_mask:0xf bank_mask:0xf
    v_dot2c_f32_bf16_dpp v9, v4, v84 row_newbcast:5 row_mask:0xf bank_mask:0xf
    v_dot2c_f32_bf16_dpp v10, v4, v80 row_newbcast:5 row_mask:0xf bank_mask:0xf
    v_dot2c_f32_bf16_dpp v11, v4, v85 row_newbcast:5 row_mask:0xf bank_mask:0xf
    v_dot2c_f32_bf16_dpp v12, v4, v81 row_newbcast:5 row_mask:0xf bank_mask:0xf
    v_dot2c_f32_bf16_dpp v13, v4, v86 row_newbcast:5 row_mask:0xf bank_mask:0xf
    v_dot2c_f32_bf16_dpp v14, v4, v82 row_newbcast:5 row_mask:0xf bank_mask:0xf
    v_dot2c_f32_bf16_dpp v15, v4, v87 row_newbcast:5 row_mask:0xf bank_mask:0xf
    v_dot2c_f32_bf16_dpp v8, v4, v83 row_newbcast:6 row_mask:0xf bank_mask:0xf
    v_dot2c_f32_bf16_dpp v9, v4, v92 row_newbcast:6 row_mask:0xf bank_mask:0xf
    v_dot2c_f32_bf16_dpp v10, v4, v88 row_newbcast:6 row_mask:0xf bank_mask:0xf
    v_dot2c_f32_bf16_dpp v11, v4, v93 row_newbcast:6 row_mask:0xf bank_mask:0xf
    v_dot2c_f32_bf16_dpp v12, v4, v89 row_newbcast:6 row_mask:0xf bank_mask:0xf
    v_dot2c_f32_bf16_dpp v13, v4, v94 row_newbcast:6 row_mask:0xf bank_mask:0xf
    v_dot2c_f32_bf16_dpp v14, v4, v90 row_newbcast:6 row_mask:0xf bank_mask:0xf
    v_dot2c_f32_bf16_dpp v15, v4, v95 row_newbcast:6 row_mask:0xf bank_mask:0xf
    v_dot2c_f32_bf16_dpp v8, v4, v91 row_newbcast:7 row_mask:0xf bank_mask:0xf
    v_dot2c_f32_bf16_dpp v9, v4, v100 row_newbcast:7 row_mask:0xf bank_mask:0xf
    v_dot2c_f32_bf16_dpp v10, v4, v96 row_newbcast:7 row_mask:0xf bank_mask:0xf
    v_dot2c_f32_bf16_dpp v11, v4, v101 row_newbcast:7 row_mask:0xf bank_mask:0xf
    v_dot2c_f32_bf16_dpp v12, v4, v97 row_newbcast:7 row_mask:0xf bank_mask:0xf
    v_dot2c_f32_bf16_dpp v13, v4, v102 row_newbcast:7 row_mask:0xf bank_mask:0xf
    v_dot2c_f32_bf16_dpp v14, v4, v98 row_newbcast:7 row_mask:0xf bank_mask:0xf
    v_dot2c_f32_bf16_dpp v15, v4, v103 row_newbcast:7 row_mask:0xf bank_mask:0xf
    v_dot2c_f32_bf16_dpp v8, v4, v99 row_newbcast:8 row_mask:0xf bank_mask:0xf
    v_dot2c_f32_bf16_dpp v9, v4, v108 row_newbcast:8 row_mask:0xf bank_mask:0xf
    v_dot2c_f32_bf16_dpp v10, v4, v104 row_newbcast:8 row_mask:0xf bank_mask:0xf
    v_dot2c_f32_bf16_dpp v11, v4, v109 row_newbcast:8 row_mask:0xf bank_mask:0xf
    v_dot2c_f32_bf16_dpp v12, v4, v105 row_newbcast:8 row_mask:0xf bank_mask:0xf
    v_dot2c_f32_bf16_dpp v13, v4, v110 row_newbcast:8 row_mask:0xf bank_mask:0xf
    v_dot2c_f32_bf16_dpp v14, v4, v106 row_newbcast:8 row_mask:0xf bank_mask:0xf
    v_dot2c_f32_bf16_dpp v15, v4, v111 row_newbcast:8 row_mask:0xf bank_mask:0xf
    v_dot2c_f32_bf16_dpp v8, v4, v107 row_newbcast:9 row_mask:0xf bank_mask:0xf
    v_dot2c_f32_bf16_dpp v9, v4, v116 row_newbcast:9 row_mask:0xf bank_mask:0xf
    v_dot2c_f32_bf16_dpp v10, v4, v112 row_newbcast:9 row_mask:0xf bank_mask:0xf
    v_dot2c_f32_bf16_dpp v11, v4, v117 row_newbcast:9 row_mask:0xf bank_mask:0xf
    v_dot2c_f32_bf16_dpp v12, v4, v113 row_newbcast:9 row_mask:0xf bank_mask:0xf
    v_dot2c_f32_bf16_dpp v13, v4, v118 row_newbcast:9 row_mask:0xf bank_mask:0xf
    v_dot2c_f32_bf16_dpp v14, v4, v114 row_newbcast:9 row_mask:0xf bank_mask:0xf
    v_dot2c_f32_bf16_dpp v15, v4, v119 row_newbcast:9 row_mask:0xf bank_mask:0xf
    v_dot2c_f32_bf16_dpp v8, v4, v115 row_newbcast:10 row_mask:0xf bank_mask:0xf
    v_dot2c_f32_bf16_dpp v9, v4, v124 row_newbcast:10 row_mask:0xf bank_mask:0xf
    v_dot2c_f32_bf16_dpp v10, v4, v120 row_newbcast:10 row_mask:0xf bank_mask:0xf
    v_dot2c_f32_bf16_dpp v11, v4, v125 row_newbcast:10 row_mask:0xf bank_mask:0xf
    v_dot2c_f32_bf16_dpp v12, v4, v121 row_newbcast:10 row_mask:0xf bank_mask:0xf
    v_dot2c_f32_bf16_dpp v13, v4, v126 row_newbcast:10 row_mask:0xf bank_mask:0xf
    v_dot2c_f32_bf16_dpp v14, v4, v122 row_newbcast:10 row_mask:0xf bank_mask:0xf
    v_dot2c_f32_bf16_dpp v15, v4, v127 row_newbcast:10 row_mask:0xf bank_mask:0xf
    v_dot2c_f32_bf16_dpp v8, v4, v123 row_newbcast:11 row_mask:0xf bank_mask:0xf
    v_dot2c_f32_bf16_dpp v9, v4, v132 row_newbcast:11 row_mask:0xf bank_mask:0xf
    v_dot2c_f32_bf16_dpp v10, v4, v128 row_newbcast:11 row_mask:0xf bank_mask:0xf
    v_dot2c_f32_bf16_dpp v11, v4, v133 row_newbcast:11 row_mask:0xf bank_mask:0xf
    v_dot2c_f32_bf16_dpp v12, v4, v129 row_newbcast:11 row_mask:0xf bank_mask:0xf
    v_dot2c_f32_bf16_dpp v13, v4, v134 row_newbcast:11 row_mask:0xf bank_mask:0xf
    v_dot2c_f32_bf16_dpp v14, v4, v130 row_newbcast:11 row_mask:0xf bank_mask:0xf
    v_dot2c_f32_bf16_dpp v15, v4, v135 row_newbcast:11 row_mask:0xf bank_mask:0xf
    v_dot2c_f32_bf16_dpp v8, v4, v131 row_newbcast:12 row_mask:0xf bank_mask:0xf
    v_dot2c_f32_bf16_dpp v9, v4, v140 row_newbcast:12 row_mask:0xf bank_mask:0xf
    v_dot2c_f32_bf16_dpp v10, v4, v136 row_newbcast:12 row_mask:0xf bank_mask:0xf
    v_dot2c_f32_bf16_dpp v11, v4, v141 row_newbcast:12 row_mask:0xf bank_mask:0xf
    v_dot2c_f32_bf16_dpp v12, v4, v137 row_newbcast:12 row_mask:0xf bank_mask:0xf
    v_dot2c_f32_bf16_dpp v13, v4, v142 row_newbcast:12 row_mask:0xf bank_mask:0xf
    v_dot2c_f32_bf16_dpp v14, v4, v138 row_newbcast:12 row_mask:0xf bank_mask:0xf
    v_dot2c_f32_bf16_dpp v15, v4, v143 row_newbcast:12 row_mask:0xf bank_mask:0xf
    v_dot2c_f32_bf16_dpp v8, v4, v139 row_newbcast:13 row_mask:0xf bank_mask:0xf
    v_dot2c_f32_bf16_dpp v9, v4, v148 row_newbcast:13 row_mask:0xf bank_mask:0xf
    v_dot2c_f32_bf16_dpp v10, v4, v144 row_newbcast:13 row_mask:0xf bank_mask:0xf
    v_dot2c_f32_bf16_dpp v11, v4, v149 row_newbcast:13 row_mask:0xf bank_mask:0xf
    v_dot2c_f32_bf16_dpp v12, v4, v145 row_newbcast:13 row_mask:0xf bank_mask:0xf
    v_dot2c_f32_bf16_dpp v13, v4, v150 row_newbcast:13 row_mask:0xf bank_mask:0xf
    v_dot2c_f32_bf16_dpp v14, v4, v146 row_newbcast:13 row_mask:0xf bank_mask:0xf
    v_dot2c_f32_bf16_dpp v15, v4, v151 row_newbcast:13 row_mask:0xf bank_mask:0xf
    v_dot2c_f32_bf16_dpp v8, v4, v147 row_newbcast:14 row_mask:0xf bank_mask:0xf
    v_dot2c_f32_bf16_dpp v9, v4, v156 row_newbcast:14 row_mask:0xf bank_mask:0xf
    v_dot2c_f32_bf16_dpp v10, v4, v152 row_newbcast:14 row_mask:0xf bank_mask:0xf
    v_dot2c_f32_bf16_dpp v11, v4, v157 row_newbcast:14 row_mask:0xf bank_mask:0xf
    v_dot2c_f32_bf16_dpp v12, v4, v153 row_newbcast:14 row_mask:0xf bank_mask:0xf
    v_dot2c_f32_bf16_dpp v13, v4, v158 row_newbcast:14 row_mask:0xf bank_mask:0xf
    v_dot2c_f32_bf16_dpp v14, v4, v154 row_newbcast:14 row_mask:0xf bank_mask:0xf
    v_dot2c_f32_bf16_dpp v15, v4, v159 row_newbcast:14 row_mask:0xf bank_mask:0xf
    v_dot2c_f32_bf16_dpp v8, v4, v155 row_newbcast:15 row_mask:0xf bank_mask:0xf
    v_dot2c_f32_bf16_dpp v9, v4, v164 row_newbcast:15 row_mask:0xf bank_mask:0xf
    v_dot2c_f32_bf16_dpp v10, v4, v160 row_newbcast:15 row_mask:0xf bank_mask:0xf
    v_dot2c_f32_bf16_dpp v11, v4, v165 row_newbcast:15 row_mask:0xf bank_mask:0xf
    v_dot2c_f32_bf16_dpp v12, v4, v161 row_newbcast:15 row_mask:0xf bank_mask:0xf
    v_dot2c_f32_bf16_dpp v13, v4, v166 row_newbcast:15 row_mask:0xf bank_mask:0xf
    v_dot2c_f32_bf16_dpp v14, v4, v162 row_newbcast:15 row_mask:0xf bank_mask:0xf
    v_dot2c_f32_bf16_dpp v15, v4, v167 row_newbcast:15 row_mask:0xf bank_mask:0xf
    s_cmp_eq_u32 s37, 2
    s_cbranch_scc1 L_after2
    v_permlane32_swap_b32 v8, v12
    v_permlane32_swap_b32 v9, v13
    v_permlane32_swap_b32 v10, v14
    v_permlane32_swap_b32 v11, v15
    v_pk_add_f32 v[10:11], v[10:11], v[14:15]
    v_pk_add_f32 v[8:9], v[8:9], v[12:13]
    s_nop 1
    v_permlane16_swap_b32 v8, v10
    v_permlane16_swap_b32 v9, v11
    v_pk_add_f32 v[8:9], v[8:9], v[10:11]
    s_cmp_lt_u32 s37, 2
    s_cbranch_scc1 L_after01
    v_min_u32 v8, -2, v8
    v_min_u32 v9, -2, v9
    global_store_dwordx2 v6, v[8:9], s[24:25] sc1
    s_cmp_ge_u32 s52, 4
    s_cbranch_scc1 L_hend
    v_mov_b32 v40, -1
    v_mov_b32 v41, -1
    v_mov_b32 v42, -1
    v_mov_b32 v43, -1
    buffer_load_dwordx4 v[40:43], v38, s[32:35], 0 offen sc1
    v_mov_b32 v44, -1
    v_mov_b32 v45, -1
    v_mov_b32 v46, -1
    v_mov_b32 v47, -1
    buffer_load_dwordx4 v[44:47], v38, s[32:35], s45 offen sc1
    v_mov_b32 v48, -1
    v_mov_b32 v49, -1
    v_mov_b32 v50, -1
    v_mov_b32 v51, -1
    buffer_load_dwordx4 v[48:51], v38, s[32:35], s46 offen sc1
    v_mov_b32 v52, -1
    v_mov_b32 v53, -1
    v_mov_b32 v54, -1
    v_mov_b32 v55, -1
    buffer_load_dwordx4 v[52:55], v38, s[32:35], s57 offen sc1
    s_mov_b32 s56, 0
    s_mov_b32 s39, 0
    v_lshlrev_b32 v37, 16, v37
L_poll:
    s_waitcnt vmcnt(2)
    v_max3_u32 v28, v40, v41, v42
    v_max_u32 v28, v28, v43
    v_cmp_eq_u32 s[48:49], -1, v28
    v_max3_u32 v29, v44, v45, v46
    v_max_u32 v29, v29, v47
    v_cmp_eq_u32 s[50:51], -1, v29
    v_max3_u32 v30, v48, v49, v50
    v_max_u32 v30, v30, v51
    v_cmp_eq_u32 s[54:55], -1, v30
    v_max3_u32 v31, v52, v53, v54
    v_max_u32 v31, v31, v55
    v_cmp_eq_u32 s[58:59], -1, v31
    s_or_b64 s[42:43], s[48:49], s[50:51]
    s_or_b64 s[42:43], s[42:43], s[54:55]
    s_or_b64 s[42:43], s[42:43], s[58:59]
    s_cbranch_scc1 L_again
L_pdone:
    v_pk_add_f32 v[16:17], v[40:41], v[44:45]
    v_pk_add_f32 v[20:21], v[48:49], v[52:53]
    v_pk_add_f32 v[18:19], v[42:43], v[46:47]
    v_pk_add_f32 v[22:23], v[50:51], v[54:55]
    v_pk_add_f32 v[16:17], v[16:17], v[20:21]
    v_pk_add_f32 v[18:19], v[18:19], v[22:23]
    s_nop 1
    v_permlane32_swap_b32 v16, v18
    v_permlane32_swap_b32 v17, v19
    v_pk_add_f32 v[16:17], v[16:17], v[18:19]
    s_nop 1
    v_permlane16_swap_b32 v16, v17
    v_add_f32 v16, v16, v17
    s_nop 1
    v_add_f32_dpp v16, v16, v16 row_ror:8 row_mask:0xf bank_mask:0xf
    v_cmp_u_f32 vcc, v16, v16
    v_add_f32 v16, v16, v37
    v_cvt_pk_bf16_f32 v16, v16, v16
    s_cbranch_vccnz L_nan
L_store:
    s_mov_b32 exec_lo, 0x00ff00ff
    s_mov_b32 exec_hi, 0x00ff00ff
    global_store_short v36, v16, s[20:21]
L_hend:
L_end:
    s_endpgm
L_again:
    s_mov_b64 exec, s[48:49]
    s_cbranch_execz L_psk0
    buffer_load_dwordx4 v[40:43], v38, s[32:35], 0 offen sc1
L_psk0:
    s_mov_b64 exec, s[50:51]
    s_cbranch_execz L_psk1
    buffer_load_dwordx4 v[44:47], v38, s[32:35], s45 offen sc1
L_psk1:
    s_mov_b64 exec, s[54:55]
    s_cbranch_execz L_psk2
    buffer_load_dwordx4 v[48:51], v38, s[32:35], s46 offen sc1
L_psk2:
    s_mov_b64 exec, s[58:59]
    s_cbranch_execz L_psk3
    buffer_load_dwordx4 v[52:55], v38, s[32:35], s57 offen sc1
L_psk3:
    s_mov_b64 exec, -1
    s_mov_b32 s39, 0
    s_add_u32 s56, s56, 1
    s_cmp_lt_u32 s56, 0x400000
    s_cbranch_scc1 L_poll
    s_mov_b32 s39, 1
    s_branch L_pdone
L_nan:
    s_cmp_lg_u32 s39, 0
    s_cbranch_scc1 L_store
    s_waitcnt vmcnt(0)
    s_mov_b32 s39, 1
    s_branch L_poll
L_silu:
    v_and_b32 v17, s44, v4
    v_lshlrev_b32 v16, 16, v4
    v_mul_f32 v18, 0xbfb8aa3b, v16
    v_mul_f32 v19, 0xbfb8aa3b, v17
    v_exp_f32 v18, v18
    v_exp_f32 v19, v19
    s_nop 0
    v_add_f32 v18, 1.0, v18
    v_add_f32 v19, 1.0, v19
    v_rcp_f32 v18, v18
    v_rcp_f32 v19, v19
    s_nop 0
    v_mul_f32 v16, v16, v18
    v_mul_f32 v17, v17, v19
    v_cvt_pk_bf16_f32 v4, v16, v17
    s_nop 0
    s_branch L_dots
L_after2:
    global_load_ushort v37, v36, s[4:5]
    v_add_u32 v7, 2048, v7
    s_lshl_b32 s38, s27, 17
    s_add_u32 s28, s12, s38
    s_addc_u32 s29, s13, 0
    s_mov_b32 s30, 0x20000
    s_mov_b32 s37, 3
    s_branch L_pass
L_after01:
    s_cmp_eq_u32 s37, 1
    s_cbranch_scc1 L_after1
    ds_write_b64 v6, v[8:9] offset:0
    s_waitcnt lgkmcnt(0)
    s_barrier
    s_cmp_ge_u32 s52, 4
    s_cbranch_scc1 L_noflag
    s_cmp_lg_u32 s3, 0
    s_cbranch_scc1 L_noflag
    s_lshl_b32 s38, s26, 2
    s_add_u32 s38, s38, s52
    s_lshl_b32 s38, s38, 2
    v_mov_b32 v35, s38
    v_mov_b32 v33, 1
    s_mov_b64 exec, 1
    global_store_dword v35, v33, s[22:23] sc1
    s_mov_b64 exec, -1
L_noflag:
    s_lshl_b32 s38, s27, 7
    s_add_u32 s28, s16, s38
    s_addc_u32 s29, s17, 0
    s_sub_u32 s30, 1835008, s38
    s_cmp_lt_u32 s27, 28
    s_cselect_b32 s30, s30, 0
    s_mov_b32 s47, 3584
    s_mov_b32 s38, 114688
    v_mul_lo_u32 v1, v32, s38
    v_lshl_add_u32 v1, v2, 4, v1
    v_and_b32 v16, 8, v2
    v_lshl_add_u32 v1, v16, 24, v1
    s_mov_b32 s37, 1
    s_branch L_pass0
L_after1:
    ds_write_b64 v6, v[8:9] offset:2048
    s_lshl_b32 s38, s2, 11
    s_lshl_b32 s39, s3, 9
    s_add_u32 s38, s38, s39
    v_lshl_add_u32 v6, v0, 3, s38
    s_lshl_b32 s38, s27, 16
    s_cmp_lt_u32 s27, 28
    s_cselect_b32 s30, 0x10000, 0
    s_cselect_b32 s38, s38, 0
    s_add_u32 s28, s18, s38
    s_addc_u32 s29, s19, 0
    s_mov_b32 s47, 1024
    v_lshlrev_b32 v1, 15, v3
    v_lshl_add_u32 v1, v2, 4, v1
    s_lshl_b32 s38, s3, 8
    v_add_u32 v1, s38, v1
    s_mov_b32 s37, 2
    s_waitcnt lgkmcnt(0)
L_pass0:
    v_mov_b32 v8, 0
    v_mov_b32 v9, 0
    v_mov_b32 v10, 0
    v_mov_b32 v11, 0
    v_mov_b32 v12, 0
    v_mov_b32 v13, 0
    v_mov_b32 v14, 0
    v_mov_b32 v15, 0
L_pass:
    s_lshl_b32 s38, s26, 2
    s_mul_i32 s36, s38, s47
    s_lshl_b32 s39, s47, 5
    s_waitcnt vmcnt(1)
    buffer_load_dwordx4 v[40:43], v1, s[28:31], s36 offen
    s_add_u32 s36, s36, s47
    s_waitcnt vmcnt(1)
    buffer_load_dwordx4 v[44:47], v1, s[28:31], s36 offen
    s_add_u32 s36, s36, s47
    s_waitcnt vmcnt(1)
    buffer_load_dwordx4 v[48:51], v1, s[28:31], s36 offen
    s_add_u32 s36, s36, s47
    s_waitcnt vmcnt(1)
    buffer_load_dwordx4 v[52:55], v1, s[28:31], s36 offen
    s_add_u32 s36, s36, s47
    s_cmp_eq_u32 s36, s39
    s_cselect_b32 s36, 0, s36
    s_waitcnt vmcnt(1)
    buffer_load_dwordx4 v[56:59], v1, s[28:31], s36 offen
    s_add_u32 s36, s36, s47
    s_waitcnt vmcnt(1)
    buffer_load_dwordx4 v[60:63], v1, s[28:31], s36 offen
    s_add_u32 s36, s36, s47
    s_waitcnt vmcnt(1)
    buffer_load_dwordx4 v[64:67], v1, s[28:31], s36 offen
    s_add_u32 s36, s36, s47
    s_waitcnt vmcnt(1)
    buffer_load_dwordx4 v[68:71], v1, s[28:31], s36 offen
    s_add_u32 s36, s36, s47
    s_cmp_eq_u32 s36, s39
    s_cselect_b32 s36, 0, s36
    s_waitcnt vmcnt(1)
    buffer_load_dwordx4 v[72:75], v1, s[28:31], s36 offen
    s_add_u32 s36, s36, s47
    s_waitcnt vmcnt(1)
    buffer_load_dwordx4 v[76:79], v1, s[28:31], s36 offen
    s_add_u32 s36, s36, s47
    s_waitcnt vmcnt(1)
    buffer_load_dwordx4 v[80:83], v1, s[28:31], s36 offen
    s_add_u32 s36, s36, s47
    s_waitcnt vmcnt(1)
    buffer_load_dwordx4 v[84:87], v1, s[28:31], s36 offen
    s_add_u32 s36, s36, s47
    s_cmp_eq_u32 s36, s39
    s_cselect_b32 s36, 0, s36
    s_waitcnt vmcnt(1)
    buffer_load_dwordx4 v[88:91], v1, s[28:31], s36 offen
    s_add_u32 s36, s36, s47
    s_waitcnt vmcnt(1)
    buffer_load_dwordx4 v[92:95], v1, s[28:31], s36 offen
    s_add_u32 s36, s36, s47
    s_waitcnt vmcnt(1)
    buffer_load_dwordx4 v[96:99], v1, s[28:31], s36 offen
    s_add_u32 s36, s36, s47
    s_waitcnt vmcnt(1)
    buffer_load_dwordx4 v[100:103], v1, s[28:31], s36 offen
    s_add_u32 s36, s36, s47
    s_cmp_eq_u32 s36, s39
    s_cselect_b32 s36, 0, s36
    s_waitcnt vmcnt(1)
    buffer_load_dwordx4 v[104:107], v1, s[28:31], s36 offen
    s_add_u32 s36, s36, s47
    s_waitcnt vmcnt(1)
    buffer_load_dwordx4 v[108:111], v1, s[28:31], s36 offen
    s_add_u32 s36, s36, s47
    s_waitcnt vmcnt(1)
    buffer_load_dwordx4 v[112:115], v1, s[28:31], s36 offen
    s_add_u32 s36, s36, s47
    s_waitcnt vmcnt(1)
    buffer_load_dwordx4 v[116:119], v1, s[28:31], s36 offen
    s_add_u32 s36, s36, s47
    s_cmp_eq_u32 s36, s39
    s_cselect_b32 s36, 0, s36
    s_waitcnt vmcnt(1)
    buffer_load_dwordx4 v[120:123], v1, s[28:31], s36 offen
    s_add_u32 s36, s36, s47
    s_waitcnt vmcnt(1)
    buffer_load_dwordx4 v[124:127], v1, s[28:31], s36 offen
    s_add_u32 s36, s36, s47
    s_waitcnt vmcnt(1)
    buffer_load_dwordx4 v[128:131], v1, s[28:31], s36 offen
    s_add_u32 s36, s36, s47
    s_waitcnt vmcnt(1)
    buffer_load_dwordx4 v[132:135], v1, s[28:31], s36 offen
    s_add_u32 s36, s36, s47
    s_cmp_eq_u32 s36, s39
    s_cselect_b32 s36, 0, s36
    s_waitcnt vmcnt(1)
    buffer_load_dwordx4 v[136:139], v1, s[28:31], s36 offen
    s_add_u32 s36, s36, s47
    s_waitcnt vmcnt(1)
    buffer_load_dwordx4 v[140:143], v1, s[28:31], s36 offen
    s_add_u32 s36, s36, s47
    s_waitcnt vmcnt(1)
    buffer_load_dwordx4 v[144:147], v1, s[28:31], s36 offen
    s_add_u32 s36, s36, s47
    s_waitcnt vmcnt(1)
    buffer_load_dwordx4 v[148:151], v1, s[28:31], s36 offen
    s_add_u32 s36, s36, s47
    s_cmp_eq_u32 s36, s39
    s_cselect_b32 s36, 0, s36
    s_waitcnt vmcnt(1)
    buffer_load_dwordx4 v[152:155], v1, s[28:31], s36 offen
    s_add_u32 s36, s36, s47
    s_waitcnt vmcnt(1)
    buffer_load_dwordx4 v[156:159], v1, s[28:31], s36 offen
    s_add_u32 s36, s36, s47
    s_waitcnt vmcnt(1)
    buffer_load_dwordx4 v[160:163], v1, s[28:31], s36 offen
    s_add_u32 s36, s36, s47
    s_waitcnt vmcnt(1)
    buffer_load_dwordx4 v[164:167], v1, s[28:31], s36 offen
    s_branch L_perm
L_ctrl:
    s_load_dwordx4 s[20:23], s[0:1], 64
    s_load_dwordx2 s[24:25], s[0:1], 80
    s_getpc_b64 s[42:43]
L_pc:
    s_sub_u32 s42, s42, L_pc-parallel_sum__mha_block_cached__dense_activation_silu__decode_kernel
    s_subb_u32 s43, s43, 0
    s_lshr_b32 s38, s2, 3
    s_lshl_b32 s38, s38, 10
    s_min_u32 s38, s38, L_codeend-parallel_sum__mha_block_cached__dense_activation_silu__decode_kernel-1024
    v_lshl_add_u32 v20, v0, 4, s38
    global_load_dwordx4 v[16:19], v20, s[42:43]
    v_lshlrev_b32 v4, 4, v0
    v_mov_b32 v12, 0
    v_mov_b32 v13, 0
    v_mov_b32 v14, 0
    v_mov_b32 v15, 0
    ds_write_b128 v4, v[12:15] offset:6400
    v_and_b32 v3, 3, v0
    v_lshlrev_b32 v3, 8, v3
    v_mov_b32 v5, 1
    ds_write_b32 v3, v5 offset:7424
    s_getreg_b32 s38, hwreg(HW_REG_XCC_ID)
    s_and_b32 s38, s38, 7
    s_bitcmp1_b32 s38, 0
    s_cselect_b32 s36, 30, 34
    s_mul_i32 s38, s38, 4352
    s_add_u32 s38, s38, 524288
    v_lshl_add_u32 v1, v0, 2, s38
    s_lshr_b32 s50, s2, 3
    s_lshl_b32 s39, s50, 2
    s_add_u32 s39, s39, s38
    v_mov_b32 v2, s39
    s_add_u32 s39, s38, 128
    v_mov_b32 v8, s39
    s_add_u32 s39, s38, 0x10000
    v_and_b32 v9, 15, v0
    v_lshl_add_u32 v9, v9, 2, s39
    s_mov_b32 s48, 99
    s_mov_b32 s49, 1
    s_mov_b32 s92, -30
    s_mov_b32 s93, -30
    s_mov_b32 s94, -30
    s_mov_b32 s95, -30
    s_mov_b32 s96, -30
    s_mov_b32 s97, -30
    s_mov_b32 s98, -30
    s_mov_b32 s99, -30
    s_mov_b32 s40, 896
    s_mov_b32 s41, 0
    s_waitcnt lgkmcnt(0)
    s_add_u32 s42, s24, 589824
    s_addc_u32 s43, s25, 0
    s_barrier
    s_barrier
    s_barrier
L_cw:
    ds_read_b32 v5, v3 offset:6400
    s_waitcnt lgkmcnt(0)
    v_readfirstlane_b32 s39, v5
    s_cmp_lt_u32 s39, 40
    s_cbranch_scc1 L_cw
    v_and_b32 v6, 31, v0
    v_lshlrev_b32 v6, 2, v6
    s_mov_b32 s44, 0
L_chk:
    global_load_dword v4, v6, s[22:23] sc1
    s_add_u32 s44, s44, 1
    s_cmp_ge_u32 s44, 0x100000
    s_cbranch_scc1 L_chkd
    s_waitcnt vmcnt(0)
    v_cmp_eq_u32 vcc, 0, v4
    s_cbranch_vccnz L_chk
L_chkd:
    s_mov_b32 exec_hi, 15
L_ctl:
    global_load_dword v4, v1, s[24:25] sc1
    s_cmp_lg_u32 s50, 0
    s_cbranch_scc1 L_nl1
    s_load_dword s76, s[42:43], 0 glc
    s_load_dword s77, s[42:43], 4352 glc
    s_load_dword s78, s[42:43], 8704 glc
    s_load_dword s79, s[42:43], 13056 glc
    s_load_dword s80, s[42:43], 17408 glc
    s_load_dword s81, s[42:43], 21760 glc
    s_load_dword s82, s[42:43], 26112 glc
    s_load_dword s83, s[42:43], 30464 glc
L_nl1:
    s_waitcnt vmcnt(0) lgkmcnt(0)
    ds_read_b32 v5, v3 offset:6400
    v_cmp_eq_u32 vcc, 0, v4
    v_readlane_b32 s45, v4, 32
    s_nop 1
    v_add_u32_dpp v4, v4, v4 row_ror:8 row_mask:0xf bank_mask:0xf
    s_nop 1
    v_add_u32_dpp v4, v4, v4 row_ror:4 row_mask:0xf bank_mask:0xf
    s_nop 1
    v_add_u32_dpp v4, v4, v4 row_ror:2 row_mask:0xf bank_mask:0xf
    s_nop 1
    v_add_u32_dpp v4, v4, v4 row_ror:1 row_mask:0xf bank_mask:0xf
    s_waitcnt lgkmcnt(0)
    v_add_u32_dpp v6, v5, v5 quad_perm:[1,0,3,2] row_mask:0xf bank_mask:0xf
    v_lshlrev_b32 v7, 2, v5
    s_nop 0
    v_add_u32_dpp v5, v6, v6 quad_perm:[2,3,0,1] row_mask:0xf bank_mask:0xf
    global_store_dword v2, v5, s[24:25]
    v_readfirstlane_b32 s39, v5
    v_readlane_b32 s38, v4, 0
    v_readlane_b32 s47, v4, 16
    s_cmp_lg_u32 vcc_lo, 0
    s_cbranch_scc1 L_ctls
    s_sub_u32 s41, s41, 1
    s_cmp_ge_i32 s41, 0
    s_cbranch_scc1 L_ctls
    s_add_u32 s38, s38, s47
    s_lshr_b32 s56, s38, 5
    s_add_u32 s38, s56, s36
    s_add_u32 s38, s38, s45
    v_sub_u32 v7, s38, v7
    v_mov_b32 v4, 0
    v_cmp_le_i32 vcc, -12, v7
    s_nop 1
    v_addc_co_u32 v4, vcc, 0, v4, vcc
    v_cmp_le_i32 vcc, 12, v7
    s_nop 1
    v_addc_co_u32 v4, vcc, 0, v4, vcc
    v_cmp_le_i32 vcc, 32, v7
    s_nop 1
    v_addc_co_u32 v4, vcc, 0, v4, vcc
    ds_write_b32 v3, v4 offset:7424
    s_cmp_lg_u32 s50, 0
    s_cbranch_scc1 L_ctls
    s_cmp_lt_u32 s39, 1200
    s_cselect_b32 s47, 10, 5
    s_add_u32 s48, s48, 1
    s_cmp_lt_u32 s48, s47
    s_cbranch_scc1 L_nl2
    s_mov_b32 s48, 0
    v_mov_b32 v6, s56
    global_store_dword v9, v6, s[24:25] sc1
L_nl2:
    s_cmp_eq_u32 s49, 0
    s_cbranch_scc1 L_nf
    s_mov_b64 s[84:85], s[76:77]
    s_mov_b64 s[86:87], s[78:79]
    s_mov_b64 s[88:89], s[80:81]
    s_mov_b64 s[90:91], s[82:83]
    s_mov_b32 s49, 0
L_nf:
    s_mov_b32 s38, 240
    s_sub_u32 s47, s76, s56
    s_cmp_lg_u32 s76, s84
    s_cselect_b32 s92, s47, s92
    s_mov_b32 s84, s76
    s_add_u32 s38, s38, s92
    s_sub_u32 s47, s77, s56
    s_cmp_lg_u32 s77, s85
    s_cselect_b32 s93, s47, s93
    s_mov_b32 s85, s77
    s_add_u32 s38, s38, s93
    s_sub_u32 s47, s78, s56
    s_cmp_lg_u32 s78, s86
    s_cselect_b32 s94, s47, s94
    s_mov_b32 s86, s78
    s_add_u32 s38, s38, s94
    s_sub_u32 s47, s79, s56
    s_cmp_lg_u32 s79, s87
    s_cselect_b32 s95, s47, s95
    s_mov_b32 s87, s79
    s_add_u32 s38, s38, s95
    s_sub_u32 s47, s80, s56
    s_cmp_lg_u32 s80, s88
    s_cselect_b32 s96, s47, s96
    s_mov_b32 s88, s80
    s_add_u32 s38, s38, s96
    s_sub_u32 s47, s81, s56
    s_cmp_lg_u32 s81, s89
    s_cselect_b32 s97, s47, s97
    s_mov_b32 s89, s81
    s_add_u32 s38, s38, s97
    s_sub_u32 s47, s82, s56
    s_cmp_lg_u32 s82, s90
    s_cselect_b32 s98, s47, s98
    s_mov_b32 s90, s82
    s_add_u32 s38, s38, s98
    s_sub_u32 s47, s83, s56
    s_cmp_lg_u32 s83, s91
    s_cselect_b32 s99, s47, s99
    s_mov_b32 s91, s83
    s_add_u32 s38, s38, s99
    s_ashr_i32 s38, s38, 4
    s_min_i32 s38, s38, 12
    s_max_i32 s38, s38, -12
    v_mov_b32 v7, s38
    global_store_dword v8, v7, s[24:25]
L_ctls:
    s_cmp_lt_u32 s39, s40
    s_cbranch_scc1 L_ctl
    s_cmp_eq_u32 s40, 1856
    s_cbranch_scc1 L_end
    s_mov_b32 s40, 1856
    s_mov_b32 s41, 1
    s_mov_b32 s49, 1
    s_barrier
    s_branch L_ctl
L_stream:
    s_setprio 1
    s_lshl_b32 s52, s26, 2
    s_add_u32 s52, s52, s3
    s_mul_i32 s52, s52, 57344
    s_lshl_b32 s53, s27, 7
    s_add_u32 s52, s52, s53
    v_lshrrev_b32 v3, 3, v0
    v_mul_u32_u24 v3, 3584, v3
    v_and_b32 v2, 7, v0
    v_lshl_add_u32 v3, v2, 4, v3
    v_add_u32 v3, s52, v3
    v_add_u32 v4, 28672, v3
    s_lshl_b32 s52, s27, 3
    s_add_u32 s52, s52, s26
    s_lshl_b32 s52, s52, 2
    s_add_u32 s52, s52, s3
    s_lshl_b32 s53, s52, 11
    v_lshl_add_u32 v5, v0, 4, s53
    s_lshl_b32 s53, s52, 12
    v_lshl_add_u32 v6, v0, 4, s53
    s_waitcnt lgkmcnt(0)
    s_and_b32 s38, s3, 1
    s_lshl_b32 s38, s38, 11
    s_lshr_b32 s39, s3, 1
    s_lshl_b32 s39, s39, 16
    s_or_b32 s38, s38, s39
    v_and_b32 v2, 15, v0
    v_lshl_add_u32 v1, v2, 4, s38
    v_bfe_u32 v7, v0, 4, 1
    v_lshl_add_u32 v1, v7, 13, v1
    v_bfe_u32 v7, v0, 5, 1
    v_lshl_add_u32 v1, v7, 15, v1
    v_lshlrev_b32 v2, 5, v2
    s_lshl_b32 s38, s2, 20
    s_add_u32 s28, s6, s38
    s_addc_u32 s29, s7, 0
    s_add_u32 s8, s8, s38
    s_addc_u32 s9, s9, 0
    s_mov_b32 s30, 0x100000
    s_mov_b32 s51, 0
    s_mov_b32 s37, 0
    s_mov_b32 s48, 0xb0b0202
    s_mov_b32 s49, 0x1b1b1313
    s_bfe_u32 s53, s2, 0x10000
    s_lshl_b32 s39, s53, 3
    s_bfe_u32 s53, s2, 0x10007
    s_lshl_b32 s53, s53, 4
    s_or_b32 s39, s39, s53
    s_bfe_u32 s53, s2, 0x10003
    s_lshl_b32 s53, s53, 5
    s_or_b32 s39, s39, s53
    s_lshr_b64 s[48:49], s[48:49], s39
    s_and_b32 s48, s48, 0xff
    s_mov_b32 s40, 0xcccccccc
    s_mov_b32 s41, 0xcccccccc
    s_mov_b32 s42, 0xaaaaaaaa
    s_mov_b32 s43, 0xaaaaaaaa
    s_mov_b32 s44, 0xffff0000
    s_mov_b32 s45, 0x3db504f3
    s_mov_b32 s46, 0x3fb8aa3b
    s_lshl_b32 s38, s3, 8
    v_lshl_add_u32 v36, v0, 2, s38
    v_mov_b32 v37, 2
    s_cmp_ge_u32 s27, 28
    s_cbranch_scc1 L_pf2
    global_load_dwordx4 v[16:19], v3, s[16:17]
    global_load_dwordx4 v[20:23], v4, s[16:17]
    global_load_dwordx4 v[24:27], v5, s[18:19]
    global_load_dwordx4 v[28:31], v5, s[18:19] offset:1024
L_pf2:
    global_load_dwordx4 v[16:19], v6, s[12:13]
    s_waitcnt vmcnt(4)
    global_load_dwordx4 v[20:23], v6, s[12:13] offset:1024
    s_waitcnt vmcnt(4)
    global_load_dwordx4 v[24:27], v6, s[12:13] offset:2048
    s_waitcnt vmcnt(4)
    global_load_dwordx4 v[28:31], v6, s[12:13] offset:3072
    s_waitcnt vmcnt(6)
    buffer_load_dwordx4 v[40:43], v1, s[28:31], s51 offen nt
    s_waitcnt vmcnt(6)
    s_add_u32 s36, s51, 0x4000
    buffer_load_dwordx4 v[44:47], v1, s[28:31], s36 offen nt
    s_cmp_lg_u32 s48, 2
    s_cbranch_scc1 L_nb2
    s_barrier
    s_barrier
L_nb2:
    s_waitcnt vmcnt(6)
    buffer_load_dwordx4 v[48:51], v1, s[28:31], s51 offen offset:512 nt
    s_waitcnt vmcnt(6)
    buffer_load_dwordx4 v[52:55], v1, s[28:31], s36 offen offset:512 nt
    s_waitcnt vmcnt(6)
    buffer_load_dwordx4 v[56:59], v1, s[28:31], s51 offen offset:256 nt
    s_waitcnt vmcnt(6)
    buffer_load_dwordx4 v[60:63], v1, s[28:31], s36 offen offset:256 nt
    s_waitcnt vmcnt(6)
    buffer_load_dwordx4 v[64:67], v1, s[28:31], s51 offen offset:768 nt
    s_waitcnt vmcnt(6)
    buffer_load_dwordx4 v[68:71], v1, s[28:31], s36 offen offset:768 nt
    s_waitcnt vmcnt(6)
    s_add_u32 s36, s51, 0x1000
    buffer_load_dwordx4 v[72:75], v1, s[28:31], s36 offen nt
    s_waitcnt vmcnt(6)
    s_add_u32 s36, s51, 0x5000
    buffer_load_dwordx4 v[76:79], v1, s[28:31], s36 offen nt
    s_waitcnt vmcnt(6)
    s_add_u32 s36, s51, 0x1000
    buffer_load_dwordx4 v[80:83], v1, s[28:31], s36 offen offset:512 nt
    s_cmp_lg_u32 s48, 11
    s_cbranch_scc1 L_nb11
    s_barrier
    s_barrier
L_nb11:
    s_waitcnt vmcnt(6)
    s_add_u32 s36, s51, 0x5000
    buffer_load_dwordx4 v[84:87], v1, s[28:31], s36 offen offset:512 nt
    s_waitcnt vmcnt(6)
    s_add_u32 s36, s51, 0x1000
    buffer_load_dwordx4 v[88:91], v1, s[28:31], s36 offen offset:256 nt
    s_waitcnt vmcnt(6)
    s_add_u32 s36, s51, 0x5000
    buffer_load_dwordx4 v[92:95], v1, s[28:31], s36 offen offset:256 nt
    s_waitcnt vmcnt(6)
    s_add_u32 s36, s51, 0x1000
    buffer_load_dwordx4 v[96:99], v1, s[28:31], s36 offen offset:768 nt
    s_waitcnt vmcnt(6)
    s_add_u32 s36, s51, 0x5000
    buffer_load_dwordx4 v[100:103], v1, s[28:31], s36 offen offset:768 nt
    s_waitcnt vmcnt(6)
    s_add_u32 s36, s51, 0x20000
    buffer_load_dwordx4 v[104:107], v1, s[28:31], s36 offen nt
    s_waitcnt vmcnt(6)
    s_add_u32 s36, s51, 0x24000
    buffer_load_dwordx4 v[108:111], v1, s[28:31], s36 offen nt
    s_waitcnt vmcnt(6)
    s_add_u32 s36, s51, 0x20000
    buffer_load_dwordx4 v[112:115], v1, s[28:31], s36 offen offset:512 nt
    s_cmp_lg_u32 s48, 19
    s_cbranch_scc1 L_nb19
    s_barrier
    s_barrier
L_nb19:
    s_waitcnt vmcnt(6)
    s_add_u32 s36, s51, 0x24000
    buffer_load_dwordx4 v[116:119], v1, s[28:31], s36 offen offset:512 nt
    s_waitcnt vmcnt(6)
    s_add_u32 s36, s51, 0x20000
    buffer_load_dwordx4 v[120:123], v1, s[28:31], s36 offen offset:256 nt
    s_waitcnt vmcnt(6)
    s_add_u32 s36, s51, 0x24000
    buffer_load_dwordx4 v[124:127], v1, s[28:31], s36 offen offset:256 nt
    s_waitcnt vmcnt(6)
    s_add_u32 s36, s51, 0x20000
    buffer_load_dwordx4 v[128:131], v1, s[28:31], s36 offen offset:768 nt
    s_waitcnt vmcnt(6)
    s_add_u32 s36, s51, 0x24000
    buffer_load_dwordx4 v[132:135], v1, s[28:31], s36 offen offset:768 nt
    s_waitcnt vmcnt(6)
    s_add_u32 s36, s51, 0x21000
    buffer_load_dwordx4 v[136:139], v1, s[28:31], s36 offen nt
    s_waitcnt vmcnt(6)
    s_add_u32 s36, s51, 0x25000
    buffer_load_dwordx4 v[140:143], v1, s[28:31], s36 offen nt
    s_waitcnt vmcnt(6)
    s_add_u32 s36, s51, 0x21000
    buffer_load_dwordx4 v[144:147], v1, s[28:31], s36 offen offset:512 nt
    s_cmp_lg_u32 s48, 27
    s_cbranch_scc1 L_nb27
    s_barrier
    s_barrier
L_nb27:
    s_waitcnt vmcnt(6)
    s_add_u32 s36, s51, 0x25000
    buffer_load_dwordx4 v[148:151], v1, s[28:31], s36 offen offset:512 nt
    s_waitcnt vmcnt(6)
    s_add_u32 s36, s51, 0x21000
    buffer_load_dwordx4 v[152:155], v1, s[28:31], s36 offen offset:256 nt
    s_waitcnt vmcnt(6)
    s_add_u32 s36, s51, 0x25000
    buffer_load_dwordx4 v[156:159], v1, s[28:31], s36 offen offset:256 nt
    s_waitcnt vmcnt(6)
    s_add_u32 s36, s51, 0x21000
    buffer_load_dwordx4 v[160:163], v1, s[28:31], s36 offen offset:768 nt
    s_waitcnt vmcnt(6)
    s_add_u32 s36, s51, 0x25000
    buffer_load_dwordx4 v[164:167], v1, s[28:31], s36 offen offset:768 nt
    s_barrier
    ds_read_b128 v[16:19], v2 offset:0
    ds_read_b128 v[20:23], v2 offset:16
    ds_read_b128 v[24:27], v2 offset:512
    ds_read_b128 v[28:31], v2 offset:528
    ds_read_b128 v[8:11], v2 offset:1024
    ds_read_b128 v[12:15], v2 offset:1040
    ds_read_b128 v[4:7], v2 offset:1536
    ds_read_b128 v[32:35], v2 offset:1552
    s_mov_b32 s48, 1
    s_waitcnt lgkmcnt(4)
    v_add_f32 v16, v16, v24
    v_add_f32 v17, v17, v25
    v_add_f32 v18, v18, v26
    v_add_f32 v19, v19, v27
    v_add_f32 v20, v20, v28
    v_add_f32 v21, v21, v29
    v_add_f32 v22, v22, v30
    v_add_f32 v23, v23, v31
    s_waitcnt lgkmcnt(0)
    v_add_f32 v8, v8, v4
    v_add_f32 v9, v9, v5
    v_add_f32 v10, v10, v6
    v_add_f32 v11, v11, v7
    v_add_f32 v12, v12, v32
    v_add_f32 v13, v13, v33
    v_add_f32 v14, v14, v34
    v_add_f32 v15, v15, v35
    v_add_f32 v16, v16, v8
    v_add_f32 v17, v17, v9
    v_add_f32 v18, v18, v10
    v_add_f32 v19, v19, v11
    v_add_f32 v20, v20, v12
    v_add_f32 v21, v21, v13
    v_add_f32 v22, v22, v14
    v_add_f32 v23, v23, v15
    v_cvt_pk_bf16_f32 v4, v16, v17
    v_cvt_pk_bf16_f32 v5, v18, v19
    v_cvt_pk_bf16_f32 v6, v20, v21
    v_cvt_pk_bf16_f32 v7, v22, v23
L_kloop:
    s_add_u32 s52, s37, 1
    s_bfe_u32 s53, s52, 0x10000
    s_lshl_b32 s51, s53, 18
    s_bfe_u32 s53, s52, 0x10001
    s_lshl_b32 s53, s53, 19
    s_or_b32 s51, s51, s53
    s_bfe_u32 s53, s52, 0x10002
    s_lshl_b32 s53, s53, 10
    s_or_b32 s51, s51, s53
    s_cmp_eq_u32 s48, 0
    s_cbranch_scc1 L_k0_0
    s_cmp_eq_u32 s48, 2
    s_cbranch_scc1 L_k0_2
    s_cmp_eq_u32 s48, 3
    s_cbranch_scc1 L_k0_3
L_k0_1:
    v_dot2_f32_bf16 v16, v40, v4, 0
    v_dot2_f32_bf16 v16, v41, v5, v16
    v_dot2_f32_bf16 v16, v42, v6, v16
    v_dot2_f32_bf16 v16, v43, v7, v16
    s_waitcnt vmcnt(4)
    buffer_load_dwordx4 v[40:43], v1, s[28:31], s51 offen nt
    ds_add_u32 v36, v37 offset:6400
    v_dot2_f32_bf16 v17, v44, v4, 0
    v_dot2_f32_bf16 v17, v45, v5, v17
    v_dot2_f32_bf16 v17, v46, v6, v17
    v_dot2_f32_bf16 v17, v47, v7, v17
    s_waitcnt vmcnt(4)
    s_add_u32 s36, s51, 0x4000
    buffer_load_dwordx4 v[44:47], v1, s[28:31], s36 offen nt
    v_dot2_f32_bf16 v18, v48, v4, 0
    v_dot2_f32_bf16 v18, v49, v5, v18
    v_dot2_f32_bf16 v18, v50, v6, v18
    v_dot2_f32_bf16 v18, v51, v7, v18
    s_waitcnt vmcnt(4)
    buffer_load_dwordx4 v[48:51], v1, s[28:31], s51 offen offset:512 nt
    ds_add_u32 v36, v37 offset:6400
    v_dot2_f32_bf16 v19, v52, v4, 0
    v_dot2_f32_bf16 v19, v53, v5, v19
    v_dot2_f32_bf16 v19, v54, v6, v19
    v_dot2_f32_bf16 v19, v55, v7, v19
    s_waitcnt vmcnt(4)
    buffer_load_dwordx4 v[52:55], v1, s[28:31], s36 offen offset:512 nt
    v_dot2_f32_bf16 v20, v56, v4, 0
    v_dot2_f32_bf16 v20, v57, v5, v20
    v_dot2_f32_bf16 v20, v58, v6, v20
    v_dot2_f32_bf16 v20, v59, v7, v20
    s_waitcnt vmcnt(4)
    buffer_load_dwordx4 v[56:59], v1, s[28:31], s51 offen offset:256 nt
    ds_add_u32 v36, v37 offset:6400
    v_dot2_f32_bf16 v21, v60, v4, 0
    v_dot2_f32_bf16 v21, v61, v5, v21
    v_dot2_f32_bf16 v21, v62, v6, v21
    v_dot2_f32_bf16 v21, v63, v7, v21
    s_waitcnt vmcnt(4)
    buffer_load_dwordx4 v[60:63], v1, s[28:31], s36 offen offset:256 nt
    v_dot2_f32_bf16 v22, v64, v4, 0
    v_dot2_f32_bf16 v22, v65, v5, v22
    v_dot2_f32_bf16 v22, v66, v6, v22
    v_dot2_f32_bf16 v22, v67, v7, v22
    s_waitcnt vmcnt(4)
    buffer_load_dwordx4 v[64:67], v1, s[28:31], s51 offen offset:768 nt
    ds_add_u32 v36, v37 offset:6400
    ds_read_b32 v38, v36 offset:7424
    v_dot2_f32_bf16 v23, v68, v4, 0
    v_dot2_f32_bf16 v23, v69, v5, v23
    v_dot2_f32_bf16 v23, v70, v6, v23
    v_dot2_f32_bf16 v23, v71, v7, v23
    s_waitcnt vmcnt(4)
    buffer_load_dwordx4 v[68:71], v1, s[28:31], s36 offen offset:768 nt
    s_waitcnt lgkmcnt(0)
    v_readfirstlane_b32 s48, v38
L_kj0:
    s_cmp_eq_u32 s48, 0
    s_cbranch_scc1 L_k1_0
    s_cmp_eq_u32 s48, 2
    s_cbranch_scc1 L_k1_2
    s_cmp_eq_u32 s48, 3
    s_cbranch_scc1 L_k1_3
L_k1_1:
    v_dot2_f32_bf16 v24, v72, v4, 0
    v_dot2_f32_bf16 v24, v73, v5, v24
    v_dot2_f32_bf16 v24, v74, v6, v24
    v_dot2_f32_bf16 v24, v75, v7, v24
    s_waitcnt vmcnt(4)
    s_add_u32 s36, s51, 0x1000
    buffer_load_dwordx4 v[72:75], v1, s[28:31], s36 offen nt
    ds_add_u32 v36, v37 offset:6400
    v_dot2_f32_bf16 v25, v76, v4, 0
    v_dot2_f32_bf16 v25, v77, v5, v25
    v_dot2_f32_bf16 v25, v78, v6, v25
    v_dot2_f32_bf16 v25, v79, v7, v25
    s_waitcnt vmcnt(4)
    s_add_u32 s36, s51, 0x5000
    buffer_load_dwordx4 v[76:79], v1, s[28:31], s36 offen nt
    v_dot2_f32_bf16 v26, v80, v4, 0
    v_dot2_f32_bf16 v26, v81, v5, v26
    v_dot2_f32_bf16 v26, v82, v6, v26
    v_dot2_f32_bf16 v26, v83, v7, v26
    s_waitcnt vmcnt(4)
    s_add_u32 s36, s51, 0x1000
    buffer_load_dwordx4 v[80:83], v1, s[28:31], s36 offen offset:512 nt
    ds_add_u32 v36, v37 offset:6400
    v_dot2_f32_bf16 v27, v84, v4, 0
    v_dot2_f32_bf16 v27, v85, v5, v27
    v_dot2_f32_bf16 v27, v86, v6, v27
    v_dot2_f32_bf16 v27, v87, v7, v27
    s_waitcnt vmcnt(4)
    s_add_u32 s36, s51, 0x5000
    buffer_load_dwordx4 v[84:87], v1, s[28:31], s36 offen offset:512 nt
    v_dot2_f32_bf16 v28, v88, v4, 0
    v_dot2_f32_bf16 v28, v89, v5, v28
    v_dot2_f32_bf16 v28, v90, v6, v28
    v_dot2_f32_bf16 v28, v91, v7, v28
    s_waitcnt vmcnt(4)
    s_add_u32 s36, s51, 0x1000
    buffer_load_dwordx4 v[88:91], v1, s[28:31], s36 offen offset:256 nt
    ds_add_u32 v36, v37 offset:6400
    v_dot2_f32_bf16 v29, v92, v4, 0
    v_dot2_f32_bf16 v29, v93, v5, v29
    v_dot2_f32_bf16 v29, v94, v6, v29
    v_dot2_f32_bf16 v29, v95, v7, v29
    s_waitcnt vmcnt(4)
    s_add_u32 s36, s51, 0x5000
    buffer_load_dwordx4 v[92:95], v1, s[28:31], s36 offen offset:256 nt
    v_dot2_f32_bf16 v30, v96, v4, 0
    v_dot2_f32_bf16 v30, v97, v5, v30
    v_dot2_f32_bf16 v30, v98, v6, v30
    v_dot2_f32_bf16 v30, v99, v7, v30
    s_waitcnt vmcnt(4)
    s_add_u32 s36, s51, 0x1000
    buffer_load_dwordx4 v[96:99], v1, s[28:31], s36 offen offset:768 nt
    ds_add_u32 v36, v37 offset:6400
    ds_read_b32 v38, v36 offset:7424
    v_dot2_f32_bf16 v31, v100, v4, 0
    v_dot2_f32_bf16 v31, v101, v5, v31
    v_dot2_f32_bf16 v31, v102, v6, v31
    v_dot2_f32_bf16 v31, v103, v7, v31
    s_waitcnt vmcnt(4)
    s_add_u32 s36, s51, 0x5000
    buffer_load_dwordx4 v[100:103], v1, s[28:31], s36 offen offset:768 nt
    s_waitcnt lgkmcnt(0)
    v_readfirstlane_b32 s48, v38
L_kj1:
    v_add_f32_dpp v16, v16, v16 row_ror:8 row_mask:0xf bank_mask:0x3
    v_add_f32_dpp v17, v17, v17 row_ror:8 row_mask:0xf bank_mask:0x3
    v_add_f32_dpp v18, v18, v18 row_ror:8 row_mask:0xf bank_mask:0x3
    v_add_f32_dpp v19, v19, v19 row_ror:8 row_mask:0xf bank_mask:0x3
    v_add_f32_dpp v20, v20, v20 row_ror:8 row_mask:0xf bank_mask:0x3
    v_add_f32_dpp v21, v21, v21 row_ror:8 row_mask:0xf bank_mask:0x3
    v_add_f32_dpp v22, v22, v22 row_ror:8 row_mask:0xf bank_mask:0x3
    v_add_f32_dpp v23, v23, v23 row_ror:8 row_mask:0xf bank_mask:0x3
    v_add_f32_dpp v16, v24, v24 row_ror:8 row_mask:0xf bank_mask:0xc
    v_add_f32_dpp v17, v25, v25 row_ror:8 row_mask:0xf bank_mask:0xc
    v_add_f32_dpp v18, v26, v26 row_ror:8 row_mask:0xf bank_mask:0xc
    v_add_f32_dpp v19, v27, v27 row_ror:8 row_mask:0xf bank_mask:0xc
    v_add_f32_dpp v20, v28, v28 row_ror:8 row_mask:0xf bank_mask:0xc
    v_add_f32_dpp v21, v29, v29 row_ror:8 row_mask:0xf bank_mask:0xc
    v_add_f32_dpp v22, v30, v30 row_ror:8 row_mask:0xf bank_mask:0xc
    v_add_f32_dpp v23, v31, v31 row_ror:8 row_mask:0xf bank_mask:0xc
    v_add_f32_dpp v16, v16, v16 row_shl:4 row_mask:0xf bank_mask:0x5
    v_add_f32_dpp v17, v17, v17 row_shl:4 row_mask:0xf bank_mask:0x5
    v_add_f32_dpp v18, v18, v18 row_shl:4 row_mask:0xf bank_mask:0x5
    v_add_f32_dpp v19, v19, v19 row_shl:4 row_mask:0xf bank_mask:0x5
    v_add_f32_dpp v16, v20, v20 row_shr:4 row_mask:0xf bank_mask:0xa
    v_add_f32_dpp v17, v21, v21 row_shr:4 row_mask:0xf bank_mask:0xa
    v_add_f32_dpp v18, v22, v22 row_shr:4 row_mask:0xf bank_mask:0xa
    v_add_f32_dpp v19, v23, v23 row_shr:4 row_mask:0xf bank_mask:0xa
    v_add_f32_dpp v16, v16, v16 quad_perm:[2,3,0,1] row_mask:0xf bank_mask:0xf
    v_add_f32_dpp v17, v17, v17 quad_perm:[2,3,0,1] row_mask:0xf bank_mask:0xf
    v_add_f32_dpp v18, v18, v18 quad_perm:[2,3,0,1] row_mask:0xf bank_mask:0xf
    v_add_f32_dpp v19, v19, v19 quad_perm:[2,3,0,1] row_mask:0xf bank_mask:0xf
    v_cndmask_b32 v16, v16, v18, s[40:41]
    v_cndmask_b32 v17, v17, v19, s[40:41]
    s_nop 0
    v_add_f32_dpp v16, v16, v16 quad_perm:[1,0,3,2] row_mask:0xf bank_mask:0xf
    v_add_f32_dpp v17, v17, v17 quad_perm:[1,0,3,2] row_mask:0xf bank_mask:0xf
    v_cndmask_b32 v32, v16, v17, s[42:43]
    s_cmp_eq_u32 s48, 0
    s_cbranch_scc1 L_k2_0
    s_cmp_eq_u32 s48, 2
    s_cbranch_scc1 L_k2_2
    s_cmp_eq_u32 s48, 3
    s_cbranch_scc1 L_k2_3
L_k2_1:
    v_dot2_f32_bf16 v16, v104, v4, 0
    v_dot2_f32_bf16 v16, v105, v5, v16
    v_dot2_f32_bf16 v16, v106, v6, v16
    v_dot2_f32_bf16 v16, v107, v7, v16
    s_waitcnt vmcnt(4)
    s_add_u32 s36, s51, 0x20000
    buffer_load_dwordx4 v[104:107], v1, s[28:31], s36 offen nt
    ds_add_u32 v36, v37 offset:6400
    v_dot2_f32_bf16 v17, v108, v4, 0
    v_dot2_f32_bf16 v17, v109, v5, v17
    v_dot2_f32_bf16 v17, v110, v6, v17
    v_dot2_f32_bf16 v17, v111, v7, v17
    s_waitcnt vmcnt(4)
    s_add_u32 s36, s51, 0x24000
    buffer_load_dwordx4 v[108:111], v1, s[28:31], s36 offen nt
    v_dot2_f32_bf16 v18, v112, v4, 0
    v_dot2_f32_bf16 v18, v113, v5, v18
    v_dot2_f32_bf16 v18, v114, v6, v18
    v_dot2_f32_bf16 v18, v115, v7, v18
    s_waitcnt vmcnt(4)
    s_add_u32 s36, s51, 0x20000
    buffer_load_dwordx4 v[112:115], v1, s[28:31], s36 offen offset:512 nt
    ds_add_u32 v36, v37 offset:6400
    v_dot2_f32_bf16 v19, v116, v4, 0
    v_dot2_f32_bf16 v19, v117, v5, v19
    v_dot2_f32_bf16 v19, v118, v6, v19
    v_dot2_f32_bf16 v19, v119, v7, v19
    s_waitcnt vmcnt(4)
    s_add_u32 s36, s51, 0x24000
    buffer_load_dwordx4 v[116:119], v1, s[28:31], s36 offen offset:512 nt
    v_dot2_f32_bf16 v20, v120, v4, 0
    v_dot2_f32_bf16 v20, v121, v5, v20
    v_dot2_f32_bf16 v20, v122, v6, v20
    v_dot2_f32_bf16 v20, v123, v7, v20
    s_waitcnt vmcnt(4)
    s_add_u32 s36, s51, 0x20000
    buffer_load_dwordx4 v[120:123], v1, s[28:31], s36 offen offset:256 nt
    ds_add_u32 v36, v37 offset:6400
    v_dot2_f32_bf16 v21, v124, v4, 0
    v_dot2_f32_bf16 v21, v125, v5, v21
    v_dot2_f32_bf16 v21, v126, v6, v21
    v_dot2_f32_bf16 v21, v127, v7, v21
    s_waitcnt vmcnt(4)
    s_add_u32 s36, s51, 0x24000
    buffer_load_dwordx4 v[124:127], v1, s[28:31], s36 offen offset:256 nt
    v_dot2_f32_bf16 v22, v128, v4, 0
    v_dot2_f32_bf16 v22, v129, v5, v22
    v_dot2_f32_bf16 v22, v130, v6, v22
    v_dot2_f32_bf16 v22, v131, v7, v22
    s_waitcnt vmcnt(4)
    s_add_u32 s36, s51, 0x20000
    buffer_load_dwordx4 v[128:131], v1, s[28:31], s36 offen offset:768 nt
    ds_add_u32 v36, v37 offset:6400
    ds_read_b32 v38, v36 offset:7424
    v_dot2_f32_bf16 v23, v132, v4, 0
    v_dot2_f32_bf16 v23, v133, v5, v23
    v_dot2_f32_bf16 v23, v134, v6, v23
    v_dot2_f32_bf16 v23, v135, v7, v23
    s_waitcnt vmcnt(4)
    s_add_u32 s36, s51, 0x24000
    buffer_load_dwordx4 v[132:135], v1, s[28:31], s36 offen offset:768 nt
    s_waitcnt lgkmcnt(0)
    v_readfirstlane_b32 s48, v38
L_kj2:
    s_cmp_eq_u32 s48, 0
    s_cbranch_scc1 L_k3_0
    s_cmp_eq_u32 s48, 2
    s_cbranch_scc1 L_k3_2
    s_cmp_eq_u32 s48, 3
    s_cbranch_scc1 L_k3_3
L_k3_1:
    v_dot2_f32_bf16 v24, v136, v4, 0
    v_dot2_f32_bf16 v24, v137, v5, v24
    v_dot2_f32_bf16 v24, v138, v6, v24
    v_dot2_f32_bf16 v24, v139, v7, v24
    s_waitcnt vmcnt(4)
    s_add_u32 s36, s51, 0x21000
    buffer_load_dwordx4 v[136:139], v1, s[28:31], s36 offen nt
    ds_add_u32 v36, v37 offset:6400
    v_dot2_f32_bf16 v25, v140, v4, 0
    v_dot2_f32_bf16 v25, v141, v5, v25
    v_dot2_f32_bf16 v25, v142, v6, v25
    v_dot2_f32_bf16 v25, v143, v7, v25
    s_waitcnt vmcnt(4)
    s_add_u32 s36, s51, 0x25000
    buffer_load_dwordx4 v[140:143], v1, s[28:31], s36 offen nt
    v_dot2_f32_bf16 v26, v144, v4, 0
    v_dot2_f32_bf16 v26, v145, v5, v26
    v_dot2_f32_bf16 v26, v146, v6, v26
    v_dot2_f32_bf16 v26, v147, v7, v26
    s_waitcnt vmcnt(4)
    s_add_u32 s36, s51, 0x21000
    buffer_load_dwordx4 v[144:147], v1, s[28:31], s36 offen offset:512 nt
    ds_add_u32 v36, v37 offset:6400
    v_dot2_f32_bf16 v27, v148, v4, 0
    v_dot2_f32_bf16 v27, v149, v5, v27
    v_dot2_f32_bf16 v27, v150, v6, v27
    v_dot2_f32_bf16 v27, v151, v7, v27
    s_waitcnt vmcnt(4)
    s_add_u32 s36, s51, 0x25000
    buffer_load_dwordx4 v[148:151], v1, s[28:31], s36 offen offset:512 nt
    v_dot2_f32_bf16 v28, v152, v4, 0
    v_dot2_f32_bf16 v28, v153, v5, v28
    v_dot2_f32_bf16 v28, v154, v6, v28
    v_dot2_f32_bf16 v28, v155, v7, v28
    s_waitcnt vmcnt(4)
    s_add_u32 s36, s51, 0x21000
    buffer_load_dwordx4 v[152:155], v1, s[28:31], s36 offen offset:256 nt
    ds_add_u32 v36, v37 offset:6400
    v_dot2_f32_bf16 v29, v156, v4, 0
    v_dot2_f32_bf16 v29, v157, v5, v29
    v_dot2_f32_bf16 v29, v158, v6, v29
    v_dot2_f32_bf16 v29, v159, v7, v29
    s_waitcnt vmcnt(4)
    s_add_u32 s36, s51, 0x25000
    buffer_load_dwordx4 v[156:159], v1, s[28:31], s36 offen offset:256 nt
    v_dot2_f32_bf16 v30, v160, v4, 0
    v_dot2_f32_bf16 v30, v161, v5, v30
    v_dot2_f32_bf16 v30, v162, v6, v30
    v_dot2_f32_bf16 v30, v163, v7, v30
    s_waitcnt vmcnt(4)
    s_add_u32 s36, s51, 0x21000
    buffer_load_dwordx4 v[160:163], v1, s[28:31], s36 offen offset:768 nt
    ds_add_u32 v36, v37 offset:6400
    ds_read_b32 v38, v36 offset:7424
    v_dot2_f32_bf16 v31, v164, v4, 0
    v_dot2_f32_bf16 v31, v165, v5, v31
    v_dot2_f32_bf16 v31, v166, v6, v31
    v_dot2_f32_bf16 v31, v167, v7, v31
    s_waitcnt vmcnt(4)
    s_add_u32 s36, s51, 0x25000
    buffer_load_dwordx4 v[164:167], v1, s[28:31], s36 offen offset:768 nt
    s_waitcnt lgkmcnt(0)
    v_readfirstlane_b32 s48, v38
L_kj3:
    v_add_f32_dpp v16, v16, v16 row_ror:8 row_mask:0xf bank_mask:0x3
    v_add_f32_dpp v17, v17, v17 row_ror:8 row_mask:0xf bank_mask:0x3
    v_add_f32_dpp v18, v18, v18 row_ror:8 row_mask:0xf bank_mask:0x3
    v_add_f32_dpp v19, v19, v19 row_ror:8 row_mask:0xf bank_mask:0x3
    v_add_f32_dpp v20, v20, v20 row_ror:8 row_mask:0xf bank_mask:0x3
    v_add_f32_dpp v21, v21, v21 row_ror:8 row_mask:0xf bank_mask:0x3
    v_add_f32_dpp v22, v22, v22 row_ror:8 row_mask:0xf bank_mask:0x3
    v_add_f32_dpp v23, v23, v23 row_ror:8 row_mask:0xf bank_mask:0x3
    v_add_f32_dpp v16, v24, v24 row_ror:8 row_mask:0xf bank_mask:0xc
    v_add_f32_dpp v17, v25, v25 row_ror:8 row_mask:0xf bank_mask:0xc
    v_add_f32_dpp v18, v26, v26 row_ror:8 row_mask:0xf bank_mask:0xc
    v_add_f32_dpp v19, v27, v27 row_ror:8 row_mask:0xf bank_mask:0xc
    v_add_f32_dpp v20, v28, v28 row_ror:8 row_mask:0xf bank_mask:0xc
    v_add_f32_dpp v21, v29, v29 row_ror:8 row_mask:0xf bank_mask:0xc
    v_add_f32_dpp v22, v30, v30 row_ror:8 row_mask:0xf bank_mask:0xc
    v_add_f32_dpp v23, v31, v31 row_ror:8 row_mask:0xf bank_mask:0xc
    v_add_f32_dpp v16, v16, v16 row_shl:4 row_mask:0xf bank_mask:0x5
    v_add_f32_dpp v17, v17, v17 row_shl:4 row_mask:0xf bank_mask:0x5
    v_add_f32_dpp v18, v18, v18 row_shl:4 row_mask:0xf bank_mask:0x5
    v_add_f32_dpp v19, v19, v19 row_shl:4 row_mask:0xf bank_mask:0x5
    v_add_f32_dpp v16, v20, v20 row_shr:4 row_mask:0xf bank_mask:0xa
    v_add_f32_dpp v17, v21, v21 row_shr:4 row_mask:0xf bank_mask:0xa
    v_add_f32_dpp v18, v22, v22 row_shr:4 row_mask:0xf bank_mask:0xa
    v_add_f32_dpp v19, v23, v23 row_shr:4 row_mask:0xf bank_mask:0xa
    v_add_f32_dpp v16, v16, v16 quad_perm:[2,3,0,1] row_mask:0xf bank_mask:0xf
    v_add_f32_dpp v17, v17, v17 quad_perm:[2,3,0,1] row_mask:0xf bank_mask:0xf
    v_add_f32_dpp v18, v18, v18 quad_perm:[2,3,0,1] row_mask:0xf bank_mask:0xf
    v_add_f32_dpp v19, v19, v19 quad_perm:[2,3,0,1] row_mask:0xf bank_mask:0xf
    v_cndmask_b32 v16, v16, v18, s[40:41]
    v_cndmask_b32 v17, v17, v19, s[40:41]
    s_nop 0
    v_add_f32_dpp v16, v16, v16 quad_perm:[1,0,3,2] row_mask:0xf bank_mask:0xf
    v_add_f32_dpp v17, v17, v17 quad_perm:[1,0,3,2] row_mask:0xf bank_mask:0xf
    v_cndmask_b32 v33, v16, v17, s[42:43]
    v_cvt_pk_bf16_f32 v32, v32, v33
    v_mov_b32 v8, v9
    v_mov_b32 v9, v10
    v_mov_b32 v10, v11
    v_mov_b32 v11, v12
    v_mov_b32 v12, v13
    v_mov_b32 v13, v14
    v_mov_b32 v14, v15
    v_and_b32 v33, s44, v32
    v_lshlrev_b32 v32, 16, v32
    v_mul_f32 v33, s45, v33
    v_mul_f32 v32, s45, v32
    v_cvt_pk_bf16_f32 v15, v32, v33
    s_add_u32 s37, s37, 1
    s_cmp_lt_u32 s37, 7
    s_cbranch_scc1 L_kloop
    s_mov_b32 s28, s8
    s_mov_b32 s29, s9
    s_mov_b32 s51, 0
    v_dot2_f32_bf16 v16, v40, v4, 0
    v_dot2_f32_bf16 v16, v41, v5, v16
    v_dot2_f32_bf16 v16, v42, v6, v16
    v_dot2_f32_bf16 v16, v43, v7, v16
    v_dot2_f32_bf16 v17, v44, v4, 0
    v_dot2_f32_bf16 v17, v45, v5, v17
    v_dot2_f32_bf16 v17, v46, v6, v17
    v_dot2_f32_bf16 v17, v47, v7, v17
    v_dot2_f32_bf16 v18, v48, v4, 0
    v_dot2_f32_bf16 v18, v49, v5, v18
    v_dot2_f32_bf16 v18, v50, v6, v18
    v_dot2_f32_bf16 v18, v51, v7, v18
    v_dot2_f32_bf16 v19, v52, v4, 0
    v_dot2_f32_bf16 v19, v53, v5, v19
    v_dot2_f32_bf16 v19, v54, v6, v19
    v_dot2_f32_bf16 v19, v55, v7, v19
    s_waitcnt vmcnt(4)
    buffer_load_dwordx4 v[40:43], v1, s[28:31], s51 offen nt
    ds_add_u32 v36, v37 offset:6400
    v_dot2_f32_bf16 v20, v56, v4, 0
    v_dot2_f32_bf16 v20, v57, v5, v20
    v_dot2_f32_bf16 v20, v58, v6, v20
    v_dot2_f32_bf16 v20, v59, v7, v20
    v_dot2_f32_bf16 v21, v60, v4, 0
    v_dot2_f32_bf16 v21, v61, v5, v21
    v_dot2_f32_bf16 v21, v62, v6, v21
    v_dot2_f32_bf16 v21, v63, v7, v21
    v_dot2_f32_bf16 v22, v64, v4, 0
    v_dot2_f32_bf16 v22, v65, v5, v22
    v_dot2_f32_bf16 v22, v66, v6, v22
    v_dot2_f32_bf16 v22, v67, v7, v22
    v_dot2_f32_bf16 v23, v68, v4, 0
    v_dot2_f32_bf16 v23, v69, v5, v23
    v_dot2_f32_bf16 v23, v70, v6, v23
    v_dot2_f32_bf16 v23, v71, v7, v23
    s_waitcnt vmcnt(4)
    s_add_u32 s36, s51, 0x4000
    buffer_load_dwordx4 v[44:47], v1, s[28:31], s36 offen nt
    v_dot2_f32_bf16 v24, v72, v4, 0
    v_dot2_f32_bf16 v24, v73, v5, v24
    v_dot2_f32_bf16 v24, v74, v6, v24
    v_dot2_f32_bf16 v24, v75, v7, v24
    v_dot2_f32_bf16 v25, v76, v4, 0
    v_dot2_f32_bf16 v25, v77, v5, v25
    v_dot2_f32_bf16 v25, v78, v6, v25
    v_dot2_f32_bf16 v25, v79, v7, v25
    v_dot2_f32_bf16 v26, v80, v4, 0
    v_dot2_f32_bf16 v26, v81, v5, v26
    v_dot2_f32_bf16 v26, v82, v6, v26
    v_dot2_f32_bf16 v26, v83, v7, v26
    s_waitcnt vmcnt(4)
    buffer_load_dwordx4 v[48:51], v1, s[28:31], s51 offen offset:512 nt
    ds_add_u32 v36, v37 offset:6400
    v_dot2_f32_bf16 v27, v84, v4, 0
    v_dot2_f32_bf16 v27, v85, v5, v27
    v_dot2_f32_bf16 v27, v86, v6, v27
    v_dot2_f32_bf16 v27, v87, v7, v27
    v_dot2_f32_bf16 v28, v88, v4, 0
    v_dot2_f32_bf16 v28, v89, v5, v28
    v_dot2_f32_bf16 v28, v90, v6, v28
    v_dot2_f32_bf16 v28, v91, v7, v28
    v_dot2_f32_bf16 v29, v92, v4, 0
    v_dot2_f32_bf16 v29, v93, v5, v29
    v_dot2_f32_bf16 v29, v94, v6, v29
    v_dot2_f32_bf16 v29, v95, v7, v29
    v_dot2_f32_bf16 v30, v96, v4, 0
    v_dot2_f32_bf16 v30, v97, v5, v30
    v_dot2_f32_bf16 v30, v98, v6, v30
    v_dot2_f32_bf16 v30, v99, v7, v30
    s_waitcnt vmcnt(4)
    buffer_load_dwordx4 v[52:55], v1, s[28:31], s36 offen offset:512 nt
    v_dot2_f32_bf16 v31, v100, v4, 0
    v_dot2_f32_bf16 v31, v101, v5, v31
    v_dot2_f32_bf16 v31, v102, v6, v31
    v_dot2_f32_bf16 v31, v103, v7, v31
    v_add_f32_dpp v16, v16, v16 row_ror:8 row_mask:0xf bank_mask:0x3
    v_add_f32_dpp v17, v17, v17 row_ror:8 row_mask:0xf bank_mask:0x3
    v_add_f32_dpp v18, v18, v18 row_ror:8 row_mask:0xf bank_mask:0x3
    v_add_f32_dpp v19, v19, v19 row_ror:8 row_mask:0xf bank_mask:0x3
    v_add_f32_dpp v20, v20, v20 row_ror:8 row_mask:0xf bank_mask:0x3
    v_add_f32_dpp v21, v21, v21 row_ror:8 row_mask:0xf bank_mask:0x3
    v_add_f32_dpp v22, v22, v22 row_ror:8 row_mask:0xf bank_mask:0x3
    v_add_f32_dpp v23, v23, v23 row_ror:8 row_mask:0xf bank_mask:0x3
    v_add_f32_dpp v16, v24, v24 row_ror:8 row_mask:0xf bank_mask:0xc
    v_add_f32_dpp v17, v25, v25 row_ror:8 row_mask:0xf bank_mask:0xc
    v_add_f32_dpp v18, v26, v26 row_ror:8 row_mask:0xf bank_mask:0xc
    v_add_f32_dpp v19, v27, v27 row_ror:8 row_mask:0xf bank_mask:0xc
    v_add_f32_dpp v20, v28, v28 row_ror:8 row_mask:0xf bank_mask:0xc
    v_add_f32_dpp v21, v29, v29 row_ror:8 row_mask:0xf bank_mask:0xc
    v_add_f32_dpp v22, v30, v30 row_ror:8 row_mask:0xf bank_mask:0xc
    v_add_f32_dpp v23, v31, v31 row_ror:8 row_mask:0xf bank_mask:0xc
    v_add_f32_dpp v16, v16, v16 row_shl:4 row_mask:0xf bank_mask:0x5
    v_add_f32_dpp v17, v17, v17 row_shl:4 row_mask:0xf bank_mask:0x5
    v_add_f32_dpp v18, v18, v18 row_shl:4 row_mask:0xf bank_mask:0x5
    v_add_f32_dpp v19, v19, v19 row_shl:4 row_mask:0xf bank_mask:0x5
    v_add_f32_dpp v16, v20, v20 row_shr:4 row_mask:0xf bank_mask:0xa
    v_add_f32_dpp v17, v21, v21 row_shr:4 row_mask:0xf bank_mask:0xa
    v_add_f32_dpp v18, v22, v22 row_shr:4 row_mask:0xf bank_mask:0xa
    v_add_f32_dpp v19, v23, v23 row_shr:4 row_mask:0xf bank_mask:0xa
    v_add_f32_dpp v16, v16, v16 quad_perm:[2,3,0,1] row_mask:0xf bank_mask:0xf
    v_add_f32_dpp v17, v17, v17 quad_perm:[2,3,0,1] row_mask:0xf bank_mask:0xf
    v_add_f32_dpp v18, v18, v18 quad_perm:[2,3,0,1] row_mask:0xf bank_mask:0xf
    v_add_f32_dpp v19, v19, v19 quad_perm:[2,3,0,1] row_mask:0xf bank_mask:0xf
    v_cndmask_b32 v16, v16, v18, s[40:41]
    v_cndmask_b32 v17, v17, v19, s[40:41]
    s_nop 0
    v_add_f32_dpp v16, v16, v16 quad_perm:[1,0,3,2] row_mask:0xf bank_mask:0xf
    v_add_f32_dpp v17, v17, v17 quad_perm:[1,0,3,2] row_mask:0xf bank_mask:0xf
    v_cndmask_b32 v32, v16, v17, s[42:43]
    v_dot2_f32_bf16 v16, v104, v4, 0
    v_dot2_f32_bf16 v16, v105, v5, v16
    v_dot2_f32_bf16 v16, v106, v6, v16
    v_dot2_f32_bf16 v16, v107, v7, v16
    v_dot2_f32_bf16 v17, v108, v4, 0
    v_dot2_f32_bf16 v17, v109, v5, v17
    v_dot2_f32_bf16 v17, v110, v6, v17
    v_dot2_f32_bf16 v17, v111, v7, v17
    s_waitcnt vmcnt(4)
    buffer_load_dwordx4 v[56:59], v1, s[28:31], s51 offen offset:256 nt
    ds_add_u32 v36, v37 offset:6400
    v_dot2_f32_bf16 v18, v112, v4, 0
    v_dot2_f32_bf16 v18, v113, v5, v18
    v_dot2_f32_bf16 v18, v114, v6, v18
    v_dot2_f32_bf16 v18, v115, v7, v18
    v_dot2_f32_bf16 v19, v116, v4, 0
    v_dot2_f32_bf16 v19, v117, v5, v19
    v_dot2_f32_bf16 v19, v118, v6, v19
    v_dot2_f32_bf16 v19, v119, v7, v19
    v_dot2_f32_bf16 v20, v120, v4, 0
    v_dot2_f32_bf16 v20, v121, v5, v20
    v_dot2_f32_bf16 v20, v122, v6, v20
    v_dot2_f32_bf16 v20, v123, v7, v20
    v_dot2_f32_bf16 v21, v124, v4, 0
    v_dot2_f32_bf16 v21, v125, v5, v21
    v_dot2_f32_bf16 v21, v126, v6, v21
    v_dot2_f32_bf16 v21, v127, v7, v21
    s_waitcnt vmcnt(4)
    buffer_load_dwordx4 v[60:63], v1, s[28:31], s36 offen offset:256 nt
    v_dot2_f32_bf16 v22, v128, v4, 0
    v_dot2_f32_bf16 v22, v129, v5, v22
    v_dot2_f32_bf16 v22, v130, v6, v22
    v_dot2_f32_bf16 v22, v131, v7, v22
    v_dot2_f32_bf16 v23, v132, v4, 0
    v_dot2_f32_bf16 v23, v133, v5, v23
    v_dot2_f32_bf16 v23, v134, v6, v23
    v_dot2_f32_bf16 v23, v135, v7, v23
    v_dot2_f32_bf16 v24, v136, v4, 0
    v_dot2_f32_bf16 v24, v137, v5, v24
    v_dot2_f32_bf16 v24, v138, v6, v24
    v_dot2_f32_bf16 v24, v139, v7, v24
    s_waitcnt vmcnt(4)
    buffer_load_dwordx4 v[64:67], v1, s[28:31], s51 offen offset:768 nt
    ds_add_u32 v36, v37 offset:6400
    v_dot2_f32_bf16 v25, v140, v4, 0
    v_dot2_f32_bf16 v25, v141, v5, v25
    v_dot2_f32_bf16 v25, v142, v6, v25
    v_dot2_f32_bf16 v25, v143, v7, v25
    v_dot2_f32_bf16 v26, v144, v4, 0
    v_dot2_f32_bf16 v26, v145, v5, v26
    v_dot2_f32_bf16 v26, v146, v6, v26
    v_dot2_f32_bf16 v26, v147, v7, v26
    v_dot2_f32_bf16 v27, v148, v4, 0
    v_dot2_f32_bf16 v27, v149, v5, v27
    v_dot2_f32_bf16 v27, v150, v6, v27
    v_dot2_f32_bf16 v27, v151, v7, v27
    v_dot2_f32_bf16 v28, v152, v4, 0
    v_dot2_f32_bf16 v28, v153, v5, v28
    v_dot2_f32_bf16 v28, v154, v6, v28
    v_dot2_f32_bf16 v28, v155, v7, v28
    s_waitcnt vmcnt(4)
    buffer_load_dwordx4 v[68:71], v1, s[28:31], s36 offen offset:768 nt
    v_dot2_f32_bf16 v29, v156, v4, 0
    v_dot2_f32_bf16 v29, v157, v5, v29
    v_dot2_f32_bf16 v29, v158, v6, v29
    v_dot2_f32_bf16 v29, v159, v7, v29
    v_dot2_f32_bf16 v30, v160, v4, 0
    v_dot2_f32_bf16 v30, v161, v5, v30
    v_dot2_f32_bf16 v30, v162, v6, v30
    v_dot2_f32_bf16 v30, v163, v7, v30
    v_dot2_f32_bf16 v31, v164, v4, 0
    v_dot2_f32_bf16 v31, v165, v5, v31
    v_dot2_f32_bf16 v31, v166, v6, v31
    v_dot2_f32_bf16 v31, v167, v7, v31
    v_add_f32_dpp v16, v16, v16 row_ror:8 row_mask:0xf bank_mask:0x3
    v_add_f32_dpp v17, v17, v17 row_ror:8 row_mask:0xf bank_mask:0x3
    v_add_f32_dpp v18, v18, v18 row_ror:8 row_mask:0xf bank_mask:0x3
    v_add_f32_dpp v19, v19, v19 row_ror:8 row_mask:0xf bank_mask:0x3
    v_add_f32_dpp v20, v20, v20 row_ror:8 row_mask:0xf bank_mask:0x3
    v_add_f32_dpp v21, v21, v21 row_ror:8 row_mask:0xf bank_mask:0x3
    v_add_f32_dpp v22, v22, v22 row_ror:8 row_mask:0xf bank_mask:0x3
    v_add_f32_dpp v23, v23, v23 row_ror:8 row_mask:0xf bank_mask:0x3
    v_add_f32_dpp v16, v24, v24 row_ror:8 row_mask:0xf bank_mask:0xc
    v_add_f32_dpp v17, v25, v25 row_ror:8 row_mask:0xf bank_mask:0xc
    v_add_f32_dpp v18, v26, v26 row_ror:8 row_mask:0xf bank_mask:0xc
    v_add_f32_dpp v19, v27, v27 row_ror:8 row_mask:0xf bank_mask:0xc
    v_add_f32_dpp v20, v28, v28 row_ror:8 row_mask:0xf bank_mask:0xc
    v_add_f32_dpp v21, v29, v29 row_ror:8 row_mask:0xf bank_mask:0xc
    v_add_f32_dpp v22, v30, v30 row_ror:8 row_mask:0xf bank_mask:0xc
    v_add_f32_dpp v23, v31, v31 row_ror:8 row_mask:0xf bank_mask:0xc
    v_add_f32_dpp v16, v16, v16 row_shl:4 row_mask:0xf bank_mask:0x5
    v_add_f32_dpp v17, v17, v17 row_shl:4 row_mask:0xf bank_mask:0x5
    v_add_f32_dpp v18, v18, v18 row_shl:4 row_mask:0xf bank_mask:0x5
    v_add_f32_dpp v19, v19, v19 row_shl:4 row_mask:0xf bank_mask:0x5
    v_add_f32_dpp v16, v20, v20 row_shr:4 row_mask:0xf bank_mask:0xa
    v_add_f32_dpp v17, v21, v21 row_shr:4 row_mask:0xf bank_mask:0xa
    v_add_f32_dpp v18, v22, v22 row_shr:4 row_mask:0xf bank_mask:0xa
    v_add_f32_dpp v19, v23, v23 row_shr:4 row_mask:0xf bank_mask:0xa
    v_add_f32_dpp v16, v16, v16 quad_perm:[2,3,0,1] row_mask:0xf bank_mask:0xf
    v_add_f32_dpp v17, v17, v17 quad_perm:[2,3,0,1] row_mask:0xf bank_mask:0xf
    v_add_f32_dpp v18, v18, v18 quad_perm:[2,3,0,1] row_mask:0xf bank_mask:0xf
    v_add_f32_dpp v19, v19, v19 quad_perm:[2,3,0,1] row_mask:0xf bank_mask:0xf
    v_cndmask_b32 v16, v16, v18, s[40:41]
    v_cndmask_b32 v17, v17, v19, s[40:41]
    s_nop 0
    v_add_f32_dpp v16, v16, v16 quad_perm:[1,0,3,2] row_mask:0xf bank_mask:0xf
    v_add_f32_dpp v17, v17, v17 quad_perm:[1,0,3,2] row_mask:0xf bank_mask:0xf
    v_cndmask_b32 v33, v16, v17, s[42:43]
    s_waitcnt vmcnt(4)
    s_add_u32 s36, s51, 0x1000
    buffer_load_dwordx4 v[72:75], v1, s[28:31], s36 offen nt
    ds_add_u32 v36, v37 offset:6400
    v_cvt_pk_bf16_f32 v32, v32, v33
    v_mov_b32 v8, v9
    v_mov_b32 v9, v10
    v_mov_b32 v10, v11
    v_mov_b32 v11, v12
    v_mov_b32 v12, v13
    v_mov_b32 v13, v14
    v_mov_b32 v14, v15
    v_and_b32 v33, s44, v32
    v_lshlrev_b32 v32, 16, v32
    v_mul_f32 v33, s45, v33
    v_mul_f32 v32, s45, v32
    v_cvt_pk_bf16_f32 v15, v32, v33
    v_lshlrev_b32 v16, 16, v8
    v_and_b32 v17, s44, v8
    v_lshlrev_b32 v18, 16, v9
    v_and_b32 v19, s44, v9
    v_lshlrev_b32 v20, 16, v10
    v_and_b32 v21, s44, v10
    v_lshlrev_b32 v22, 16, v11
    v_and_b32 v23, s44, v11
    v_lshlrev_b32 v24, 16, v12
    v_and_b32 v25, s44, v12
    v_lshlrev_b32 v26, 16, v13
    v_and_b32 v27, s44, v13
    v_lshlrev_b32 v28, 16, v14
    v_and_b32 v29, s44, v14
    v_lshlrev_b32 v30, 16, v15
    v_and_b32 v31, s44, v15
    v_max_f32 v32, v16, v17
    v_max3_f32 v32, v32, v18, v19
    v_max3_f32 v32, v32, v20, v21
    v_max3_f32 v32, v32, v22, v23
    v_max3_f32 v32, v32, v24, v25
    s_waitcnt vmcnt(4)
    s_add_u32 s36, s51, 0x5000
    buffer_load_dwordx4 v[76:79], v1, s[28:31], s36 offen nt
    v_max3_f32 v32, v32, v26, v27
    v_max3_f32 v32, v32, v28, v29
    v_max3_f32 v32, v32, v30, v31
    s_nop 1
    v_max_f32_dpp v32, v32, v32 row_ror:8 row_mask:0xf bank_mask:0xf
    s_nop 1
    v_max_f32_dpp v32, v32, v32 row_ror:4 row_mask:0xf bank_mask:0xf
    s_nop 1
    v_max_f32_dpp v32, v32, v32 row_ror:2 row_mask:0xf bank_mask:0xf
    s_nop 1
    v_max_f32_dpp v32, v32, v32 row_ror:1 row_mask:0xf bank_mask:0xf
    v_mov_b32 v34, v32
    s_nop 1
    v_permlane16_swap_b32 v34, v32
    v_max_f32 v32, v32, v34
    v_mov_b32 v34, v32
    s_nop 1
    v_permlane32_swap_b32 v34, v32
    v_max_f32 v32, v32, v34
    v_sub_f32 v16, v16, v32
    v_sub_f32 v17, v17, v32
    v_sub_f32 v18, v18, v32
    v_sub_f32 v19, v19, v32
    v_sub_f32 v20, v20, v32
    v_sub_f32 v21, v21, v32
    v_sub_f32 v22, v22, v32
    v_sub_f32 v23, v23, v32
    v_sub_f32 v24, v24, v32
    v_sub_f32 v25, v25, v32
    v_sub_f32 v26, v26, v32
    v_sub_f32 v27, v27, v32
    v_sub_f32 v28, v28, v32
    v_sub_f32 v29, v29, v32
    v_sub_f32 v30, v30, v32
    s_waitcnt vmcnt(4)
    s_add_u32 s36, s51, 0x1000
    buffer_load_dwordx4 v[80:83], v1, s[28:31], s36 offen offset:512 nt
    ds_add_u32 v36, v37 offset:6400
    v_sub_f32 v31, v31, v32
    v_mul_f32 v16, s46, v16
    v_mul_f32 v17, s46, v17
    v_mul_f32 v18, s46, v18
    v_mul_f32 v19, s46, v19
    v_mul_f32 v20, s46, v20
    v_mul_f32 v21, s46, v21
    v_mul_f32 v22, s46, v22
    v_mul_f32 v23, s46, v23
    v_mul_f32 v24, s46, v24
    v_mul_f32 v25, s46, v25
    v_mul_f32 v26, s46, v26
    v_mul_f32 v27, s46, v27
    v_mul_f32 v28, s46, v28
    v_mul_f32 v29, s46, v29
    v_mul_f32 v30, s46, v30
    v_mul_f32 v31, s46, v31
    v_exp_f32 v16, v16
    v_exp_f32 v17, v17
    v_exp_f32 v18, v18
    v_exp_f32 v19, v19
    v_exp_f32 v20, v20
    v_exp_f32 v21, v21
    v_exp_f32 v22, v22
    v_exp_f32 v23, v23
    v_exp_f32 v24, v24
    v_exp_f32 v25, v25
    v_exp_f32 v26, v26
    v_exp_f32 v27, v27
    v_exp_f32 v28, v28
    v_exp_f32 v29, v29
    v_exp_f32 v30, v30
    v_exp_f32 v31, v31
    v_add_f32 v33, v16, v17
    s_waitcnt vmcnt(4)
    s_add_u32 s36, s51, 0x5000
    buffer_load_dwordx4 v[84:87], v1, s[28:31], s36 offen offset:512 nt
    v_add_f32 v33, v33, v18
    v_add_f32 v33, v33, v19
    v_add_f32 v33, v33, v20
    v_add_f32 v33, v33, v21
    v_add_f32 v33, v33, v22
    v_add_f32 v33, v33, v23
    v_add_f32 v33, v33, v24
    v_add_f32 v33, v33, v25
    v_add_f32 v33, v33, v26
    v_add_f32 v33, v33, v27
    v_add_f32 v33, v33, v28
    v_add_f32 v33, v33, v29
    v_add_f32 v33, v33, v30
    v_add_f32 v33, v33, v31
    s_nop 1
    v_add_f32_dpp v33, v33, v33 row_ror:8 row_mask:0xf bank_mask:0xf
    s_nop 1
    v_add_f32_dpp v33, v33, v33 row_ror:4 row_mask:0xf bank_mask:0xf
    s_nop 1
    v_add_f32_dpp v33, v33, v33 row_ror:2 row_mask:0xf bank_mask:0xf
    s_nop 1
    v_add_f32_dpp v33, v33, v33 row_ror:1 row_mask:0xf bank_mask:0xf
    v_mov_b32 v34, v33
    s_nop 1
    v_permlane16_swap_b32 v34, v33
    v_add_f32 v33, v33, v34
    v_mov_b32 v34, v33
    s_nop 1
    v_permlane32_swap_b32 v34, v33
    v_add_f32 v33, v33, v34
    s_lshl_b32 s38, s3, 3
    v_mov_b32 v34, s38
    ds_write_b64 v34, v[32:33] offset:6144
    v_mov_b32 v34, 0
    s_waitcnt vmcnt(5)
    s_add_u32 s36, s51, 0x1000
    buffer_load_dwordx4 v[88:91], v1, s[28:31], s36 offen offset:256 nt
    ds_add_u32 v36, v37 offset:6400
    s_waitcnt vmcnt(6)
    s_add_u32 s36, s51, 0x5000
    buffer_load_dwordx4 v[92:95], v1, s[28:31], s36 offen offset:256 nt
    s_waitcnt lgkmcnt(0)
    s_barrier
    ds_read_b128 v[8:11], v34 offset:6144
    ds_read_b128 v[12:15], v34 offset:6160
    v_lshrrev_b32 v3, 4, v0
    v_lshl_add_u32 v2, v3, 3, v2
    s_lshl_b32 s38, s3, 9
    v_add_u32 v2, s38, v2
    s_waitcnt lgkmcnt(0)
    v_max3_f32 v35, v8, v10, v12
    v_max_f32 v35, v35, v14
    v_sub_f32 v8, v8, v35
    v_sub_f32 v10, v10, v35
    v_sub_f32 v12, v12, v35
    v_sub_f32 v14, v14, v35
    v_sub_f32 v32, v32, v35
    v_mul_f32 v8, s46, v8
    v_mul_f32 v10, s46, v10
    v_mul_f32 v12, s46, v12
    v_mul_f32 v14, s46, v14
    v_mul_f32 v32, s46, v32
    v_exp_f32 v8, v8
    v_exp_f32 v10, v10
    s_waitcnt vmcnt(4)
    s_add_u32 s36, s51, 0x1000
    buffer_load_dwordx4 v[96:99], v1, s[28:31], s36 offen offset:768 nt
    ds_add_u32 v36, v37 offset:6400
    v_exp_f32 v12, v12
    v_exp_f32 v14, v14
    v_exp_f32 v32, v32
    v_mul_f32 v33, v8, v9
    v_fmac_f32 v33, v10, v11
    v_fmac_f32 v33, v12, v13
    v_fmac_f32 v33, v14, v15
    v_rcp_f32 v33, v33
    s_nop 0
    v_mul_f32 v32, v32, v33
    v_mul_f32 v16, v32, v16
    v_mul_f32 v17, v32, v17
    v_mul_f32 v18, v32, v18
    v_mul_f32 v19, v32, v19
    v_mul_f32 v20, v32, v20
    v_mul_f32 v21, v32, v21
    v_mul_f32 v22, v32, v22
    v_mul_f32 v23, v32, v23
    v_mul_f32 v24, v32, v24
    v_mul_f32 v25, v32, v25
    v_mul_f32 v26, v32, v26
    s_waitcnt vmcnt(4)
    s_add_u32 s36, s51, 0x5000
    buffer_load_dwordx4 v[100:103], v1, s[28:31], s36 offen offset:768 nt
    v_mul_f32 v27, v32, v27
    v_mul_f32 v28, v32, v28
    v_mul_f32 v29, v32, v29
    v_mul_f32 v30, v32, v30
    v_mul_f32 v31, v32, v31
    v_cvt_pk_bf16_f32 v8, v16, v17
    v_cvt_pk_bf16_f32 v9, v18, v19
    v_cvt_pk_bf16_f32 v10, v20, v21
    v_cvt_pk_bf16_f32 v11, v22, v23
    v_cvt_pk_bf16_f32 v12, v24, v25
    v_cvt_pk_bf16_f32 v13, v26, v27
    v_cvt_pk_bf16_f32 v14, v28, v29
    v_cvt_pk_bf16_f32 v15, v30, v31
    v_mov_b32 v16, 0
    v_mov_b32 v17, 0
    v_mov_b32 v18, 0
    v_mov_b32 v19, 0
    v_mov_b32 v20, 0
    v_mov_b32 v21, 0
    v_mov_b32 v22, 0
    v_mov_b32 v23, 0
    s_mov_b32 s37, 0
    s_mov_b32 s48, 1
L_vloop:
    s_add_u32 s52, s37, 1
    s_bfe_u32 s53, s52, 0x10000
    s_lshl_b32 s51, s53, 17
    s_bfe_u32 s53, s52, 0x10001
    s_lshl_b32 s53, s53, 18
    s_or_b32 s51, s51, s53
    s_bfe_u32 s53, s52, 0x10002
    s_lshl_b32 s53, s53, 19
    s_or_b32 s51, s51, s53
    s_bfe_u32 s53, s52, 0x10003
    s_lshl_b32 s53, s53, 10
    s_or_b32 s51, s51, s53
    v_and_b32 v4, 0xffff, v8
    v_lshlrev_b32 v5, 16, v8
    v_alignbit_b32 v8, v9, v8, 16
    v_alignbit_b32 v9, v10, v9, 16
    v_alignbit_b32 v10, v11, v10, 16
    v_alignbit_b32 v11, v12, v11, 16
    v_alignbit_b32 v12, v13, v12, 16
    v_alignbit_b32 v13, v14, v13, 16
    v_alignbit_b32 v14, v15, v14, 16
    v_lshrrev_b32 v15, 16, v15
    s_cmp_eq_u32 s48, 0
    s_cbranch_scc1 L_v0_0
    s_cmp_eq_u32 s48, 2
    s_cbranch_scc1 L_v0_2
    s_cmp_eq_u32 s48, 3
    s_cbranch_scc1 L_v0_3
L_v0_1:
    v_dot2c_f32_bf16_dpp v16, v4, v40 row_newbcast:0 row_mask:0xf bank_mask:0xf
    v_dot2c_f32_bf16_dpp v17, v5, v40 row_newbcast:0 row_mask:0xf bank_mask:0xf
    v_dot2c_f32_bf16_dpp v18, v4, v41 row_newbcast:0 row_mask:0xf bank_mask:0xf
    v_dot2c_f32_bf16_dpp v19, v5, v41 row_newbcast:0 row_mask:0xf bank_mask:0xf
    v_dot2c_f32_bf16_dpp v20, v4, v42 row_newbcast:0 row_mask:0xf bank_mask:0xf
    v_dot2c_f32_bf16_dpp v21, v5, v42 row_newbcast:0 row_mask:0xf bank_mask:0xf
    v_dot2c_f32_bf16_dpp v22, v4, v43 row_newbcast:0 row_mask:0xf bank_mask:0xf
    v_dot2c_f32_bf16_dpp v23, v5, v43 row_newbcast:0 row_mask:0xf bank_mask:0xf
    s_waitcnt vmcnt(4)
    buffer_load_dwordx4 v[40:43], v1, s[28:31], s51 offen nt
    ds_add_u32 v36, v37 offset:6400
    v_dot2c_f32_bf16_dpp v16, v4, v44 row_newbcast:1 row_mask:0xf bank_mask:0xf
    v_dot2c_f32_bf16_dpp v17, v5, v44 row_newbcast:1 row_mask:0xf bank_mask:0xf
    v_dot2c_f32_bf16_dpp v18, v4, v45 row_newbcast:1 row_mask:0xf bank_mask:0xf
    v_dot2c_f32_bf16_dpp v19, v5, v45 row_newbcast:1 row_mask:0xf bank_mask:0xf
    v_dot2c_f32_bf16_dpp v20, v4, v46 row_newbcast:1 row_mask:0xf bank_mask:0xf
    v_dot2c_f32_bf16_dpp v21, v5, v46 row_newbcast:1 row_mask:0xf bank_mask:0xf
    v_dot2c_f32_bf16_dpp v22, v4, v47 row_newbcast:1 row_mask:0xf bank_mask:0xf
    v_dot2c_f32_bf16_dpp v23, v5, v47 row_newbcast:1 row_mask:0xf bank_mask:0xf
    s_waitcnt vmcnt(4)
    s_add_u32 s36, s51, 0x4000
    buffer_load_dwordx4 v[44:47], v1, s[28:31], s36 offen nt
    v_dot2c_f32_bf16_dpp v16, v4, v48 row_newbcast:2 row_mask:0xf bank_mask:0xf
    v_dot2c_f32_bf16_dpp v17, v5, v48 row_newbcast:2 row_mask:0xf bank_mask:0xf
    v_dot2c_f32_bf16_dpp v18, v4, v49 row_newbcast:2 row_mask:0xf bank_mask:0xf
    v_dot2c_f32_bf16_dpp v19, v5, v49 row_newbcast:2 row_mask:0xf bank_mask:0xf
    v_dot2c_f32_bf16_dpp v20, v4, v50 row_newbcast:2 row_mask:0xf bank_mask:0xf
    v_dot2c_f32_bf16_dpp v21, v5, v50 row_newbcast:2 row_mask:0xf bank_mask:0xf
    v_dot2c_f32_bf16_dpp v22, v4, v51 row_newbcast:2 row_mask:0xf bank_mask:0xf
    v_dot2c_f32_bf16_dpp v23, v5, v51 row_newbcast:2 row_mask:0xf bank_mask:0xf
    s_waitcnt vmcnt(4)
    buffer_load_dwordx4 v[48:51], v1, s[28:31], s51 offen offset:512 nt
    ds_add_u32 v36, v37 offset:6400
    v_dot2c_f32_bf16_dpp v16, v4, v52 row_newbcast:3 row_mask:0xf bank_mask:0xf
    v_dot2c_f32_bf16_dpp v17, v5, v52 row_newbcast:3 row_mask:0xf bank_mask:0xf
    v_dot2c_f32_bf16_dpp v18, v4, v53 row_newbcast:3 row_mask:0xf bank_mask:0xf
    v_dot2c_f32_bf16_dpp v19, v5, v53 row_newbcast:3 row_mask:0xf bank_mask:0xf
    v_dot2c_f32_bf16_dpp v20, v4, v54 row_newbcast:3 row_mask:0xf bank_mask:0xf
    v_dot2c_f32_bf16_dpp v21, v5, v54 row_newbcast:3 row_mask:0xf bank_mask:0xf
    v_dot2c_f32_bf16_dpp v22, v4, v55 row_newbcast:3 row_mask:0xf bank_mask:0xf
    v_dot2c_f32_bf16_dpp v23, v5, v55 row_newbcast:3 row_mask:0xf bank_mask:0xf
    s_waitcnt vmcnt(4)
    buffer_load_dwordx4 v[52:55], v1, s[28:31], s36 offen offset:512 nt
    v_dot2c_f32_bf16_dpp v16, v4, v56 row_newbcast:4 row_mask:0xf bank_mask:0xf
    v_dot2c_f32_bf16_dpp v17, v5, v56 row_newbcast:4 row_mask:0xf bank_mask:0xf
    v_dot2c_f32_bf16_dpp v18, v4, v57 row_newbcast:4 row_mask:0xf bank_mask:0xf
    v_dot2c_f32_bf16_dpp v19, v5, v57 row_newbcast:4 row_mask:0xf bank_mask:0xf
    v_dot2c_f32_bf16_dpp v20, v4, v58 row_newbcast:4 row_mask:0xf bank_mask:0xf
    v_dot2c_f32_bf16_dpp v21, v5, v58 row_newbcast:4 row_mask:0xf bank_mask:0xf
    v_dot2c_f32_bf16_dpp v22, v4, v59 row_newbcast:4 row_mask:0xf bank_mask:0xf
    v_dot2c_f32_bf16_dpp v23, v5, v59 row_newbcast:4 row_mask:0xf bank_mask:0xf
    s_waitcnt vmcnt(4)
    buffer_load_dwordx4 v[56:59], v1, s[28:31], s51 offen offset:256 nt
    ds_add_u32 v36, v37 offset:6400
    v_dot2c_f32_bf16_dpp v16, v4, v60 row_newbcast:5 row_mask:0xf bank_mask:0xf
    v_dot2c_f32_bf16_dpp v17, v5, v60 row_newbcast:5 row_mask:0xf bank_mask:0xf
    v_dot2c_f32_bf16_dpp v18, v4, v61 row_newbcast:5 row_mask:0xf bank_mask:0xf
    v_dot2c_f32_bf16_dpp v19, v5, v61 row_newbcast:5 row_mask:0xf bank_mask:0xf
    v_dot2c_f32_bf16_dpp v20, v4, v62 row_newbcast:5 row_mask:0xf bank_mask:0xf
    v_dot2c_f32_bf16_dpp v21, v5, v62 row_newbcast:5 row_mask:0xf bank_mask:0xf
    v_dot2c_f32_bf16_dpp v22, v4, v63 row_newbcast:5 row_mask:0xf bank_mask:0xf
    v_dot2c_f32_bf16_dpp v23, v5, v63 row_newbcast:5 row_mask:0xf bank_mask:0xf
    s_waitcnt vmcnt(4)
    buffer_load_dwordx4 v[60:63], v1, s[28:31], s36 offen offset:256 nt
    v_dot2c_f32_bf16_dpp v16, v4, v64 row_newbcast:6 row_mask:0xf bank_mask:0xf
    v_dot2c_f32_bf16_dpp v17, v5, v64 row_newbcast:6 row_mask:0xf bank_mask:0xf
    v_dot2c_f32_bf16_dpp v18, v4, v65 row_newbcast:6 row_mask:0xf bank_mask:0xf
    v_dot2c_f32_bf16_dpp v19, v5, v65 row_newbcast:6 row_mask:0xf bank_mask:0xf
    v_dot2c_f32_bf16_dpp v20, v4, v66 row_newbcast:6 row_mask:0xf bank_mask:0xf
    v_dot2c_f32_bf16_dpp v21, v5, v66 row_newbcast:6 row_mask:0xf bank_mask:0xf
    v_dot2c_f32_bf16_dpp v22, v4, v67 row_newbcast:6 row_mask:0xf bank_mask:0xf
    v_dot2c_f32_bf16_dpp v23, v5, v67 row_newbcast:6 row_mask:0xf bank_mask:0xf
    s_waitcnt vmcnt(4)
    buffer_load_dwordx4 v[64:67], v1, s[28:31], s51 offen offset:768 nt
    ds_add_u32 v36, v37 offset:6400
    ds_read_b32 v38, v36 offset:7424
    v_dot2c_f32_bf16_dpp v16, v4, v68 row_newbcast:7 row_mask:0xf bank_mask:0xf
    v_dot2c_f32_bf16_dpp v17, v5, v68 row_newbcast:7 row_mask:0xf bank_mask:0xf
    v_dot2c_f32_bf16_dpp v18, v4, v69 row_newbcast:7 row_mask:0xf bank_mask:0xf
    v_dot2c_f32_bf16_dpp v19, v5, v69 row_newbcast:7 row_mask:0xf bank_mask:0xf
    v_dot2c_f32_bf16_dpp v20, v4, v70 row_newbcast:7 row_mask:0xf bank_mask:0xf
    v_dot2c_f32_bf16_dpp v21, v5, v70 row_newbcast:7 row_mask:0xf bank_mask:0xf
    v_dot2c_f32_bf16_dpp v22, v4, v71 row_newbcast:7 row_mask:0xf bank_mask:0xf
    v_dot2c_f32_bf16_dpp v23, v5, v71 row_newbcast:7 row_mask:0xf bank_mask:0xf
    s_waitcnt vmcnt(4)
    buffer_load_dwordx4 v[68:71], v1, s[28:31], s36 offen offset:768 nt
    s_waitcnt lgkmcnt(0)
    v_readfirstlane_b32 s48, v38
L_vj0:
    s_cmp_eq_u32 s48, 0
    s_cbranch_scc1 L_v1_0
    s_cmp_eq_u32 s48, 2
    s_cbranch_scc1 L_v1_2
    s_cmp_eq_u32 s48, 3
    s_cbranch_scc1 L_v1_3
L_v1_1:
    v_dot2c_f32_bf16_dpp v16, v4, v72 row_newbcast:8 row_mask:0xf bank_mask:0xf
    v_dot2c_f32_bf16_dpp v17, v5, v72 row_newbcast:8 row_mask:0xf bank_mask:0xf
    v_dot2c_f32_bf16_dpp v18, v4, v73 row_newbcast:8 row_mask:0xf bank_mask:0xf
    v_dot2c_f32_bf16_dpp v19, v5, v73 row_newbcast:8 row_mask:0xf bank_mask:0xf
    v_dot2c_f32_bf16_dpp v20, v4, v74 row_newbcast:8 row_mask:0xf bank_mask:0xf
    v_dot2c_f32_bf16_dpp v21, v5, v74 row_newbcast:8 row_mask:0xf bank_mask:0xf
    v_dot2c_f32_bf16_dpp v22, v4, v75 row_newbcast:8 row_mask:0xf bank_mask:0xf
    v_dot2c_f32_bf16_dpp v23, v5, v75 row_newbcast:8 row_mask:0xf bank_mask:0xf
    s_waitcnt vmcnt(4)
    s_add_u32 s36, s51, 0x1000
    buffer_load_dwordx4 v[72:75], v1, s[28:31], s36 offen nt
    ds_add_u32 v36, v37 offset:6400
    v_dot2c_f32_bf16_dpp v16, v4, v76 row_newbcast:9 row_mask:0xf bank_mask:0xf
    v_dot2c_f32_bf16_dpp v17, v5, v76 row_newbcast:9 row_mask:0xf bank_mask:0xf
    v_dot2c_f32_bf16_dpp v18, v4, v77 row_newbcast:9 row_mask:0xf bank_mask:0xf
    v_dot2c_f32_bf16_dpp v19, v5, v77 row_newbcast:9 row_mask:0xf bank_mask:0xf
    v_dot2c_f32_bf16_dpp v20, v4, v78 row_newbcast:9 row_mask:0xf bank_mask:0xf
    v_dot2c_f32_bf16_dpp v21, v5, v78 row_newbcast:9 row_mask:0xf bank_mask:0xf
    v_dot2c_f32_bf16_dpp v22, v4, v79 row_newbcast:9 row_mask:0xf bank_mask:0xf
    v_dot2c_f32_bf16_dpp v23, v5, v79 row_newbcast:9 row_mask:0xf bank_mask:0xf
    s_waitcnt vmcnt(4)
    s_add_u32 s36, s51, 0x5000
    buffer_load_dwordx4 v[76:79], v1, s[28:31], s36 offen nt
    v_dot2c_f32_bf16_dpp v16, v4, v80 row_newbcast:10 row_mask:0xf bank_mask:0xf
    v_dot2c_f32_bf16_dpp v17, v5, v80 row_newbcast:10 row_mask:0xf bank_mask:0xf
    v_dot2c_f32_bf16_dpp v18, v4, v81 row_newbcast:10 row_mask:0xf bank_mask:0xf
    v_dot2c_f32_bf16_dpp v19, v5, v81 row_newbcast:10 row_mask:0xf bank_mask:0xf
    v_dot2c_f32_bf16_dpp v20, v4, v82 row_newbcast:10 row_mask:0xf bank_mask:0xf
    v_dot2c_f32_bf16_dpp v21, v5, v82 row_newbcast:10 row_mask:0xf bank_mask:0xf
    v_dot2c_f32_bf16_dpp v22, v4, v83 row_newbcast:10 row_mask:0xf bank_mask:0xf
    v_dot2c_f32_bf16_dpp v23, v5, v83 row_newbcast:10 row_mask:0xf bank_mask:0xf
    s_waitcnt vmcnt(4)
    s_add_u32 s36, s51, 0x1000
    buffer_load_dwordx4 v[80:83], v1, s[28:31], s36 offen offset:512 nt
    ds_add_u32 v36, v37 offset:6400
    v_dot2c_f32_bf16_dpp v16, v4, v84 row_newbcast:11 row_mask:0xf bank_mask:0xf
    v_dot2c_f32_bf16_dpp v17, v5, v84 row_newbcast:11 row_mask:0xf bank_mask:0xf
    v_dot2c_f32_bf16_dpp v18, v4, v85 row_newbcast:11 row_mask:0xf bank_mask:0xf
    v_dot2c_f32_bf16_dpp v19, v5, v85 row_newbcast:11 row_mask:0xf bank_mask:0xf
    v_dot2c_f32_bf16_dpp v20, v4, v86 row_newbcast:11 row_mask:0xf bank_mask:0xf
    v_dot2c_f32_bf16_dpp v21, v5, v86 row_newbcast:11 row_mask:0xf bank_mask:0xf
    v_dot2c_f32_bf16_dpp v22, v4, v87 row_newbcast:11 row_mask:0xf bank_mask:0xf
    v_dot2c_f32_bf16_dpp v23, v5, v87 row_newbcast:11 row_mask:0xf bank_mask:0xf
    s_waitcnt vmcnt(4)
    s_add_u32 s36, s51, 0x5000
    buffer_load_dwordx4 v[84:87], v1, s[28:31], s36 offen offset:512 nt
    v_dot2c_f32_bf16_dpp v16, v4, v88 row_newbcast:12 row_mask:0xf bank_mask:0xf
    v_dot2c_f32_bf16_dpp v17, v5, v88 row_newbcast:12 row_mask:0xf bank_mask:0xf
    v_dot2c_f32_bf16_dpp v18, v4, v89 row_newbcast:12 row_mask:0xf bank_mask:0xf
    v_dot2c_f32_bf16_dpp v19, v5, v89 row_newbcast:12 row_mask:0xf bank_mask:0xf
    v_dot2c_f32_bf16_dpp v20, v4, v90 row_newbcast:12 row_mask:0xf bank_mask:0xf
    v_dot2c_f32_bf16_dpp v21, v5, v90 row_newbcast:12 row_mask:0xf bank_mask:0xf
    v_dot2c_f32_bf16_dpp v22, v4, v91 row_newbcast:12 row_mask:0xf bank_mask:0xf
    v_dot2c_f32_bf16_dpp v23, v5, v91 row_newbcast:12 row_mask:0xf bank_mask:0xf
    s_waitcnt vmcnt(4)
    s_add_u32 s36, s51, 0x1000
    buffer_load_dwordx4 v[88:91], v1, s[28:31], s36 offen offset:256 nt
    ds_add_u32 v36, v37 offset:6400
    v_dot2c_f32_bf16_dpp v16, v4, v92 row_newbcast:13 row_mask:0xf bank_mask:0xf
    v_dot2c_f32_bf16_dpp v17, v5, v92 row_newbcast:13 row_mask:0xf bank_mask:0xf
    v_dot2c_f32_bf16_dpp v18, v4, v93 row_newbcast:13 row_mask:0xf bank_mask:0xf
    v_dot2c_f32_bf16_dpp v19, v5, v93 row_newbcast:13 row_mask:0xf bank_mask:0xf
    v_dot2c_f32_bf16_dpp v20, v4, v94 row_newbcast:13 row_mask:0xf bank_mask:0xf
    v_dot2c_f32_bf16_dpp v21, v5, v94 row_newbcast:13 row_mask:0xf bank_mask:0xf
    v_dot2c_f32_bf16_dpp v22, v4, v95 row_newbcast:13 row_mask:0xf bank_mask:0xf
    v_dot2c_f32_bf16_dpp v23, v5, v95 row_newbcast:13 row_mask:0xf bank_mask:0xf
    s_waitcnt vmcnt(4)
    s_add_u32 s36, s51, 0x5000
    buffer_load_dwordx4 v[92:95], v1, s[28:31], s36 offen offset:256 nt
    v_dot2c_f32_bf16_dpp v16, v4, v96 row_newbcast:14 row_mask:0xf bank_mask:0xf
    v_dot2c_f32_bf16_dpp v17, v5, v96 row_newbcast:14 row_mask:0xf bank_mask:0xf
    v_dot2c_f32_bf16_dpp v18, v4, v97 row_newbcast:14 row_mask:0xf bank_mask:0xf
    v_dot2c_f32_bf16_dpp v19, v5, v97 row_newbcast:14 row_mask:0xf bank_mask:0xf
    v_dot2c_f32_bf16_dpp v20, v4, v98 row_newbcast:14 row_mask:0xf bank_mask:0xf
    v_dot2c_f32_bf16_dpp v21, v5, v98 row_newbcast:14 row_mask:0xf bank_mask:0xf
    v_dot2c_f32_bf16_dpp v22, v4, v99 row_newbcast:14 row_mask:0xf bank_mask:0xf
    v_dot2c_f32_bf16_dpp v23, v5, v99 row_newbcast:14 row_mask:0xf bank_mask:0xf
    s_waitcnt vmcnt(4)
    s_add_u32 s36, s51, 0x1000
    buffer_load_dwordx4 v[96:99], v1, s[28:31], s36 offen offset:768 nt
    ds_add_u32 v36, v37 offset:6400
    ds_read_b32 v38, v36 offset:7424
    v_dot2c_f32_bf16_dpp v16, v4, v100 row_newbcast:15 row_mask:0xf bank_mask:0xf
    v_dot2c_f32_bf16_dpp v17, v5, v100 row_newbcast:15 row_mask:0xf bank_mask:0xf
    v_dot2c_f32_bf16_dpp v18, v4, v101 row_newbcast:15 row_mask:0xf bank_mask:0xf
    v_dot2c_f32_bf16_dpp v19, v5, v101 row_newbcast:15 row_mask:0xf bank_mask:0xf
    v_dot2c_f32_bf16_dpp v20, v4, v102 row_newbcast:15 row_mask:0xf bank_mask:0xf
    v_dot2c_f32_bf16_dpp v21, v5, v102 row_newbcast:15 row_mask:0xf bank_mask:0xf
    v_dot2c_f32_bf16_dpp v22, v4, v103 row_newbcast:15 row_mask:0xf bank_mask:0xf
    v_dot2c_f32_bf16_dpp v23, v5, v103 row_newbcast:15 row_mask:0xf bank_mask:0xf
    s_waitcnt vmcnt(4)
    s_add_u32 s36, s51, 0x5000
    buffer_load_dwordx4 v[100:103], v1, s[28:31], s36 offen offset:768 nt
    s_waitcnt lgkmcnt(0)
    v_readfirstlane_b32 s48, v38
L_vj1:
    s_add_u32 s37, s37, 1
    s_cmp_lt_u32 s37, 15
    s_cbranch_scc1 L_vloop
    v_and_b32 v4, 0xffff, v8
    v_lshlrev_b32 v5, 16, v8
    s_nop 0
    v_dot2c_f32_bf16_dpp v16, v4, v40 row_newbcast:0 row_mask:0xf bank_mask:0xf
    v_dot2c_f32_bf16_dpp v17, v5, v40 row_newbcast:0 row_mask:0xf bank_mask:0xf
    v_dot2c_f32_bf16_dpp v18, v4, v41 row_newbcast:0 row_mask:0xf bank_mask:0xf
    v_dot2c_f32_bf16_dpp v19, v5, v41 row_newbcast:0 row_mask:0xf bank_mask:0xf
    v_dot2c_f32_bf16_dpp v20, v4, v42 row_newbcast:0 row_mask:0xf bank_mask:0xf
    v_dot2c_f32_bf16_dpp v21, v5, v42 row_newbcast:0 row_mask:0xf bank_mask:0xf
    v_dot2c_f32_bf16_dpp v22, v4, v43 row_newbcast:0 row_mask:0xf bank_mask:0xf
    v_dot2c_f32_bf16_dpp v23, v5, v43 row_newbcast:0 row_mask:0xf bank_mask:0xf
    v_dot2c_f32_bf16_dpp v16, v4, v44 row_newbcast:1 row_mask:0xf bank_mask:0xf
    v_dot2c_f32_bf16_dpp v17, v5, v44 row_newbcast:1 row_mask:0xf bank_mask:0xf
    v_dot2c_f32_bf16_dpp v18, v4, v45 row_newbcast:1 row_mask:0xf bank_mask:0xf
    v_dot2c_f32_bf16_dpp v19, v5, v45 row_newbcast:1 row_mask:0xf bank_mask:0xf
    v_dot2c_f32_bf16_dpp v20, v4, v46 row_newbcast:1 row_mask:0xf bank_mask:0xf
    v_dot2c_f32_bf16_dpp v21, v5, v46 row_newbcast:1 row_mask:0xf bank_mask:0xf
    v_dot2c_f32_bf16_dpp v22, v4, v47 row_newbcast:1 row_mask:0xf bank_mask:0xf
    v_dot2c_f32_bf16_dpp v23, v5, v47 row_newbcast:1 row_mask:0xf bank_mask:0xf
    v_dot2c_f32_bf16_dpp v16, v4, v48 row_newbcast:2 row_mask:0xf bank_mask:0xf
    v_dot2c_f32_bf16_dpp v17, v5, v48 row_newbcast:2 row_mask:0xf bank_mask:0xf
    v_dot2c_f32_bf16_dpp v18, v4, v49 row_newbcast:2 row_mask:0xf bank_mask:0xf
    v_dot2c_f32_bf16_dpp v19, v5, v49 row_newbcast:2 row_mask:0xf bank_mask:0xf
    v_dot2c_f32_bf16_dpp v20, v4, v50 row_newbcast:2 row_mask:0xf bank_mask:0xf
    v_dot2c_f32_bf16_dpp v21, v5, v50 row_newbcast:2 row_mask:0xf bank_mask:0xf
    v_dot2c_f32_bf16_dpp v22, v4, v51 row_newbcast:2 row_mask:0xf bank_mask:0xf
    v_dot2c_f32_bf16_dpp v23, v5, v51 row_newbcast:2 row_mask:0xf bank_mask:0xf
    v_dot2c_f32_bf16_dpp v16, v4, v52 row_newbcast:3 row_mask:0xf bank_mask:0xf
    v_dot2c_f32_bf16_dpp v17, v5, v52 row_newbcast:3 row_mask:0xf bank_mask:0xf
    v_dot2c_f32_bf16_dpp v18, v4, v53 row_newbcast:3 row_mask:0xf bank_mask:0xf
    v_dot2c_f32_bf16_dpp v19, v5, v53 row_newbcast:3 row_mask:0xf bank_mask:0xf
    v_dot2c_f32_bf16_dpp v20, v4, v54 row_newbcast:3 row_mask:0xf bank_mask:0xf
    v_dot2c_f32_bf16_dpp v21, v5, v54 row_newbcast:3 row_mask:0xf bank_mask:0xf
    v_dot2c_f32_bf16_dpp v22, v4, v55 row_newbcast:3 row_mask:0xf bank_mask:0xf
    v_dot2c_f32_bf16_dpp v23, v5, v55 row_newbcast:3 row_mask:0xf bank_mask:0xf
    v_dot2c_f32_bf16_dpp v16, v4, v56 row_newbcast:4 row_mask:0xf bank_mask:0xf
    v_dot2c_f32_bf16_dpp v17, v5, v56 row_newbcast:4 row_mask:0xf bank_mask:0xf
    v_dot2c_f32_bf16_dpp v18, v4, v57 row_newbcast:4 row_mask:0xf bank_mask:0xf
    v_dot2c_f32_bf16_dpp v19, v5, v57 row_newbcast:4 row_mask:0xf bank_mask:0xf
    v_dot2c_f32_bf16_dpp v20, v4, v58 row_newbcast:4 row_mask:0xf bank_mask:0xf
    v_dot2c_f32_bf16_dpp v21, v5, v58 row_newbcast:4 row_mask:0xf bank_mask:0xf
    v_dot2c_f32_bf16_dpp v22, v4, v59 row_newbcast:4 row_mask:0xf bank_mask:0xf
    v_dot2c_f32_bf16_dpp v23, v5, v59 row_newbcast:4 row_mask:0xf bank_mask:0xf
    v_dot2c_f32_bf16_dpp v16, v4, v60 row_newbcast:5 row_mask:0xf bank_mask:0xf
    v_dot2c_f32_bf16_dpp v17, v5, v60 row_newbcast:5 row_mask:0xf bank_mask:0xf
    v_dot2c_f32_bf16_dpp v18, v4, v61 row_newbcast:5 row_mask:0xf bank_mask:0xf
    v_dot2c_f32_bf16_dpp v19, v5, v61 row_newbcast:5 row_mask:0xf bank_mask:0xf
    v_dot2c_f32_bf16_dpp v20, v4, v62 row_newbcast:5 row_mask:0xf bank_mask:0xf
    v_dot2c_f32_bf16_dpp v21, v5, v62 row_newbcast:5 row_mask:0xf bank_mask:0xf
    v_dot2c_f32_bf16_dpp v22, v4, v63 row_newbcast:5 row_mask:0xf bank_mask:0xf
    v_dot2c_f32_bf16_dpp v23, v5, v63 row_newbcast:5 row_mask:0xf bank_mask:0xf
    v_dot2c_f32_bf16_dpp v16, v4, v64 row_newbcast:6 row_mask:0xf bank_mask:0xf
    v_dot2c_f32_bf16_dpp v17, v5, v64 row_newbcast:6 row_mask:0xf bank_mask:0xf
    v_dot2c_f32_bf16_dpp v18, v4, v65 row_newbcast:6 row_mask:0xf bank_mask:0xf
    v_dot2c_f32_bf16_dpp v19, v5, v65 row_newbcast:6 row_mask:0xf bank_mask:0xf
    v_dot2c_f32_bf16_dpp v20, v4, v66 row_newbcast:6 row_mask:0xf bank_mask:0xf
    v_dot2c_f32_bf16_dpp v21, v5, v66 row_newbcast:6 row_mask:0xf bank_mask:0xf
    v_dot2c_f32_bf16_dpp v22, v4, v67 row_newbcast:6 row_mask:0xf bank_mask:0xf
    v_dot2c_f32_bf16_dpp v23, v5, v67 row_newbcast:6 row_mask:0xf bank_mask:0xf
    v_dot2c_f32_bf16_dpp v16, v4, v68 row_newbcast:7 row_mask:0xf bank_mask:0xf
    v_dot2c_f32_bf16_dpp v17, v5, v68 row_newbcast:7 row_mask:0xf bank_mask:0xf
    v_dot2c_f32_bf16_dpp v18, v4, v69 row_newbcast:7 row_mask:0xf bank_mask:0xf
    v_dot2c_f32_bf16_dpp v19, v5, v69 row_newbcast:7 row_mask:0xf bank_mask:0xf
    v_dot2c_f32_bf16_dpp v20, v4, v70 row_newbcast:7 row_mask:0xf bank_mask:0xf
    v_dot2c_f32_bf16_dpp v21, v5, v70 row_newbcast:7 row_mask:0xf bank_mask:0xf
    v_dot2c_f32_bf16_dpp v22, v4, v71 row_newbcast:7 row_mask:0xf bank_mask:0xf
    v_dot2c_f32_bf16_dpp v23, v5, v71 row_newbcast:7 row_mask:0xf bank_mask:0xf
    v_dot2c_f32_bf16_dpp v16, v4, v72 row_newbcast:8 row_mask:0xf bank_mask:0xf
    v_dot2c_f32_bf16_dpp v17, v5, v72 row_newbcast:8 row_mask:0xf bank_mask:0xf
    v_dot2c_f32_bf16_dpp v18, v4, v73 row_newbcast:8 row_mask:0xf bank_mask:0xf
    v_dot2c_f32_bf16_dpp v19, v5, v73 row_newbcast:8 row_mask:0xf bank_mask:0xf
    v_dot2c_f32_bf16_dpp v20, v4, v74 row_newbcast:8 row_mask:0xf bank_mask:0xf
    v_dot2c_f32_bf16_dpp v21, v5, v74 row_newbcast:8 row_mask:0xf bank_mask:0xf
    v_dot2c_f32_bf16_dpp v22, v4, v75 row_newbcast:8 row_mask:0xf bank_mask:0xf
    v_dot2c_f32_bf16_dpp v23, v5, v75 row_newbcast:8 row_mask:0xf bank_mask:0xf
    s_waitcnt vmcnt(6)
    v_dot2c_f32_bf16_dpp v16, v4, v76 row_newbcast:9 row_mask:0xf bank_mask:0xf
    v_dot2c_f32_bf16_dpp v17, v5, v76 row_newbcast:9 row_mask:0xf bank_mask:0xf
    v_dot2c_f32_bf16_dpp v18, v4, v77 row_newbcast:9 row_mask:0xf bank_mask:0xf
    v_dot2c_f32_bf16_dpp v19, v5, v77 row_newbcast:9 row_mask:0xf bank_mask:0xf
    v_dot2c_f32_bf16_dpp v20, v4, v78 row_newbcast:9 row_mask:0xf bank_mask:0xf
    v_dot2c_f32_bf16_dpp v21, v5, v78 row_newbcast:9 row_mask:0xf bank_mask:0xf
    v_dot2c_f32_bf16_dpp v22, v4, v79 row_newbcast:9 row_mask:0xf bank_mask:0xf
    v_dot2c_f32_bf16_dpp v23, v5, v79 row_newbcast:9 row_mask:0xf bank_mask:0xf
    s_waitcnt vmcnt(5)
    v_dot2c_f32_bf16_dpp v16, v4, v80 row_newbcast:10 row_mask:0xf bank_mask:0xf
    v_dot2c_f32_bf16_dpp v17, v5, v80 row_newbcast:10 row_mask:0xf bank_mask:0xf
    v_dot2c_f32_bf16_dpp v18, v4, v81 row_newbcast:10 row_mask:0xf bank_mask:0xf
    v_dot2c_f32_bf16_dpp v19, v5, v81 row_newbcast:10 row_mask:0xf bank_mask:0xf
    v_dot2c_f32_bf16_dpp v20, v4, v82 row_newbcast:10 row_mask:0xf bank_mask:0xf
    v_dot2c_f32_bf16_dpp v21, v5, v82 row_newbcast:10 row_mask:0xf bank_mask:0xf
    v_dot2c_f32_bf16_dpp v22, v4, v83 row_newbcast:10 row_mask:0xf bank_mask:0xf
    v_dot2c_f32_bf16_dpp v23, v5, v83 row_newbcast:10 row_mask:0xf bank_mask:0xf
    s_waitcnt vmcnt(4)
    v_dot2c_f32_bf16_dpp v16, v4, v84 row_newbcast:11 row_mask:0xf bank_mask:0xf
    v_dot2c_f32_bf16_dpp v17, v5, v84 row_newbcast:11 row_mask:0xf bank_mask:0xf
    v_dot2c_f32_bf16_dpp v18, v4, v85 row_newbcast:11 row_mask:0xf bank_mask:0xf
    v_dot2c_f32_bf16_dpp v19, v5, v85 row_newbcast:11 row_mask:0xf bank_mask:0xf
    v_dot2c_f32_bf16_dpp v20, v4, v86 row_newbcast:11 row_mask:0xf bank_mask:0xf
    v_dot2c_f32_bf16_dpp v21, v5, v86 row_newbcast:11 row_mask:0xf bank_mask:0xf
    v_dot2c_f32_bf16_dpp v22, v4, v87 row_newbcast:11 row_mask:0xf bank_mask:0xf
    v_dot2c_f32_bf16_dpp v23, v5, v87 row_newbcast:11 row_mask:0xf bank_mask:0xf
    s_waitcnt vmcnt(3)
    v_dot2c_f32_bf16_dpp v16, v4, v88 row_newbcast:12 row_mask:0xf bank_mask:0xf
    v_dot2c_f32_bf16_dpp v17, v5, v88 row_newbcast:12 row_mask:0xf bank_mask:0xf
    v_dot2c_f32_bf16_dpp v18, v4, v89 row_newbcast:12 row_mask:0xf bank_mask:0xf
    v_dot2c_f32_bf16_dpp v19, v5, v89 row_newbcast:12 row_mask:0xf bank_mask:0xf
    v_dot2c_f32_bf16_dpp v20, v4, v90 row_newbcast:12 row_mask:0xf bank_mask:0xf
    v_dot2c_f32_bf16_dpp v21, v5, v90 row_newbcast:12 row_mask:0xf bank_mask:0xf
    v_dot2c_f32_bf16_dpp v22, v4, v91 row_newbcast:12 row_mask:0xf bank_mask:0xf
    v_dot2c_f32_bf16_dpp v23, v5, v91 row_newbcast:12 row_mask:0xf bank_mask:0xf
    s_waitcnt vmcnt(2)
    v_dot2c_f32_bf16_dpp v16, v4, v92 row_newbcast:13 row_mask:0xf bank_mask:0xf
    v_dot2c_f32_bf16_dpp v17, v5, v92 row_newbcast:13 row_mask:0xf bank_mask:0xf
    v_dot2c_f32_bf16_dpp v18, v4, v93 row_newbcast:13 row_mask:0xf bank_mask:0xf
    v_dot2c_f32_bf16_dpp v19, v5, v93 row_newbcast:13 row_mask:0xf bank_mask:0xf
    v_dot2c_f32_bf16_dpp v20, v4, v94 row_newbcast:13 row_mask:0xf bank_mask:0xf
    v_dot2c_f32_bf16_dpp v21, v5, v94 row_newbcast:13 row_mask:0xf bank_mask:0xf
    v_dot2c_f32_bf16_dpp v22, v4, v95 row_newbcast:13 row_mask:0xf bank_mask:0xf
    v_dot2c_f32_bf16_dpp v23, v5, v95 row_newbcast:13 row_mask:0xf bank_mask:0xf
    s_waitcnt vmcnt(1)
    v_dot2c_f32_bf16_dpp v16, v4, v96 row_newbcast:14 row_mask:0xf bank_mask:0xf
    v_dot2c_f32_bf16_dpp v17, v5, v96 row_newbcast:14 row_mask:0xf bank_mask:0xf
    v_dot2c_f32_bf16_dpp v18, v4, v97 row_newbcast:14 row_mask:0xf bank_mask:0xf
    v_dot2c_f32_bf16_dpp v19, v5, v97 row_newbcast:14 row_mask:0xf bank_mask:0xf
    v_dot2c_f32_bf16_dpp v20, v4, v98 row_newbcast:14 row_mask:0xf bank_mask:0xf
    v_dot2c_f32_bf16_dpp v21, v5, v98 row_newbcast:14 row_mask:0xf bank_mask:0xf
    v_dot2c_f32_bf16_dpp v22, v4, v99 row_newbcast:14 row_mask:0xf bank_mask:0xf
    v_dot2c_f32_bf16_dpp v23, v5, v99 row_newbcast:14 row_mask:0xf bank_mask:0xf
    s_waitcnt vmcnt(0)
    v_dot2c_f32_bf16_dpp v16, v4, v100 row_newbcast:15 row_mask:0xf bank_mask:0xf
    v_dot2c_f32_bf16_dpp v17, v5, v100 row_newbcast:15 row_mask:0xf bank_mask:0xf
    v_dot2c_f32_bf16_dpp v18, v4, v101 row_newbcast:15 row_mask:0xf bank_mask:0xf
    v_dot2c_f32_bf16_dpp v19, v5, v101 row_newbcast:15 row_mask:0xf bank_mask:0xf
    v_dot2c_f32_bf16_dpp v20, v4, v102 row_newbcast:15 row_mask:0xf bank_mask:0xf
    v_dot2c_f32_bf16_dpp v21, v5, v102 row_newbcast:15 row_mask:0xf bank_mask:0xf
    v_dot2c_f32_bf16_dpp v22, v4, v103 row_newbcast:15 row_mask:0xf bank_mask:0xf
    v_dot2c_f32_bf16_dpp v23, v5, v103 row_newbcast:15 row_mask:0xf bank_mask:0xf
    v_permlane32_swap_b32 v16, v20
    v_permlane32_swap_b32 v17, v21
    v_permlane32_swap_b32 v18, v22
    v_permlane32_swap_b32 v19, v23
    v_pk_add_f32 v[18:19], v[18:19], v[22:23]
    v_pk_add_f32 v[16:17], v[16:17], v[20:21]
    s_nop 1
    v_permlane16_swap_b32 v16, v18
    v_permlane16_swap_b32 v17, v19
    v_pk_add_f32 v[16:17], v[16:17], v[18:19]
    ds_write_b64 v2, v[16:17] offset:4096
    s_waitcnt lgkmcnt(0)
    s_barrier
    s_endpgm
L_v0_0:
    v_dot2c_f32_bf16_dpp v16, v4, v40 row_newbcast:0 row_mask:0xf bank_mask:0xf
    v_dot2c_f32_bf16_dpp v17, v5, v40 row_newbcast:0 row_mask:0xf bank_mask:0xf
    v_dot2c_f32_bf16_dpp v18, v4, v41 row_newbcast:0 row_mask:0xf bank_mask:0xf
    v_dot2c_f32_bf16_dpp v19, v5, v41 row_newbcast:0 row_mask:0xf bank_mask:0xf
    v_dot2c_f32_bf16_dpp v20, v4, v42 row_newbcast:0 row_mask:0xf bank_mask:0xf
    v_dot2c_f32_bf16_dpp v21, v5, v42 row_newbcast:0 row_mask:0xf bank_mask:0xf
    v_dot2c_f32_bf16_dpp v22, v4, v43 row_newbcast:0 row_mask:0xf bank_mask:0xf
    v_dot2c_f32_bf16_dpp v23, v5, v43 row_newbcast:0 row_mask:0xf bank_mask:0xf
    s_waitcnt vmcnt(3)
    buffer_load_dwordx4 v[40:43], v1, s[28:31], s51 offen nt
    ds_add_u32 v36, v37 offset:6400
    v_dot2c_f32_bf16_dpp v16, v4, v44 row_newbcast:1 row_mask:0xf bank_mask:0xf
    v_dot2c_f32_bf16_dpp v17, v5, v44 row_newbcast:1 row_mask:0xf bank_mask:0xf
    v_dot2c_f32_bf16_dpp v18, v4, v45 row_newbcast:1 row_mask:0xf bank_mask:0xf
    v_dot2c_f32_bf16_dpp v19, v5, v45 row_newbcast:1 row_mask:0xf bank_mask:0xf
    v_dot2c_f32_bf16_dpp v20, v4, v46 row_newbcast:1 row_mask:0xf bank_mask:0xf
    v_dot2c_f32_bf16_dpp v21, v5, v46 row_newbcast:1 row_mask:0xf bank_mask:0xf
    v_dot2c_f32_bf16_dpp v22, v4, v47 row_newbcast:1 row_mask:0xf bank_mask:0xf
    v_dot2c_f32_bf16_dpp v23, v5, v47 row_newbcast:1 row_mask:0xf bank_mask:0xf
    s_waitcnt vmcnt(3)
    s_add_u32 s36, s51, 0x4000
    buffer_load_dwordx4 v[44:47], v1, s[28:31], s36 offen nt
    v_dot2c_f32_bf16_dpp v16, v4, v48 row_newbcast:2 row_mask:0xf bank_mask:0xf
    v_dot2c_f32_bf16_dpp v17, v5, v48 row_newbcast:2 row_mask:0xf bank_mask:0xf
    v_dot2c_f32_bf16_dpp v18, v4, v49 row_newbcast:2 row_mask:0xf bank_mask:0xf
    v_dot2c_f32_bf16_dpp v19, v5, v49 row_newbcast:2 row_mask:0xf bank_mask:0xf
    v_dot2c_f32_bf16_dpp v20, v4, v50 row_newbcast:2 row_mask:0xf bank_mask:0xf
    v_dot2c_f32_bf16_dpp v21, v5, v50 row_newbcast:2 row_mask:0xf bank_mask:0xf
    v_dot2c_f32_bf16_dpp v22, v4, v51 row_newbcast:2 row_mask:0xf bank_mask:0xf
    v_dot2c_f32_bf16_dpp v23, v5, v51 row_newbcast:2 row_mask:0xf bank_mask:0xf
    s_waitcnt vmcnt(3)
    buffer_load_dwordx4 v[48:51], v1, s[28:31], s51 offen offset:512 nt
    ds_add_u32 v36, v37 offset:6400
    v_dot2c_f32_bf16_dpp v16, v4, v52 row_newbcast:3 row_mask:0xf bank_mask:0xf
    v_dot2c_f32_bf16_dpp v17, v5, v52 row_newbcast:3 row_mask:0xf bank_mask:0xf
    v_dot2c_f32_bf16_dpp v18, v4, v53 row_newbcast:3 row_mask:0xf bank_mask:0xf
    v_dot2c_f32_bf16_dpp v19, v5, v53 row_newbcast:3 row_mask:0xf bank_mask:0xf
    v_dot2c_f32_bf16_dpp v20, v4, v54 row_newbcast:3 row_mask:0xf bank_mask:0xf
    v_dot2c_f32_bf16_dpp v21, v5, v54 row_newbcast:3 row_mask:0xf bank_mask:0xf
    v_dot2c_f32_bf16_dpp v22, v4, v55 row_newbcast:3 row_mask:0xf bank_mask:0xf
    v_dot2c_f32_bf16_dpp v23, v5, v55 row_newbcast:3 row_mask:0xf bank_mask:0xf
    s_waitcnt vmcnt(3)
    buffer_load_dwordx4 v[52:55], v1, s[28:31], s36 offen offset:512 nt
    v_dot2c_f32_bf16_dpp v16, v4, v56 row_newbcast:4 row_mask:0xf bank_mask:0xf
    v_dot2c_f32_bf16_dpp v17, v5, v56 row_newbcast:4 row_mask:0xf bank_mask:0xf
    v_dot2c_f32_bf16_dpp v18, v4, v57 row_newbcast:4 row_mask:0xf bank_mask:0xf
    v_dot2c_f32_bf16_dpp v19, v5, v57 row_newbcast:4 row_mask:0xf bank_mask:0xf
    v_dot2c_f32_bf16_dpp v20, v4, v58 row_newbcast:4 row_mask:0xf bank_mask:0xf
    v_dot2c_f32_bf16_dpp v21, v5, v58 row_newbcast:4 row_mask:0xf bank_mask:0xf
    v_dot2c_f32_bf16_dpp v22, v4, v59 row_newbcast:4 row_mask:0xf bank_mask:0xf
    v_dot2c_f32_bf16_dpp v23, v5, v59 row_newbcast:4 row_mask:0xf bank_mask:0xf
    s_waitcnt vmcnt(3)
    buffer_load_dwordx4 v[56:59], v1, s[28:31], s51 offen offset:256 nt
    ds_add_u32 v36, v37 offset:6400
    v_dot2c_f32_bf16_dpp v16, v4, v60 row_newbcast:5 row_mask:0xf bank_mask:0xf
    v_dot2c_f32_bf16_dpp v17, v5, v60 row_newbcast:5 row_mask:0xf bank_mask:0xf
    v_dot2c_f32_bf16_dpp v18, v4, v61 row_newbcast:5 row_mask:0xf bank_mask:0xf
    v_dot2c_f32_bf16_dpp v19, v5, v61 row_newbcast:5 row_mask:0xf bank_mask:0xf
    v_dot2c_f32_bf16_dpp v20, v4, v62 row_newbcast:5 row_mask:0xf bank_mask:0xf
    v_dot2c_f32_bf16_dpp v21, v5, v62 row_newbcast:5 row_mask:0xf bank_mask:0xf
    v_dot2c_f32_bf16_dpp v22, v4, v63 row_newbcast:5 row_mask:0xf bank_mask:0xf
    v_dot2c_f32_bf16_dpp v23, v5, v63 row_newbcast:5 row_mask:0xf bank_mask:0xf
    s_waitcnt vmcnt(3)
    buffer_load_dwordx4 v[60:63], v1, s[28:31], s36 offen offset:256 nt
    v_dot2c_f32_bf16_dpp v16, v4, v64 row_newbcast:6 row_mask:0xf bank_mask:0xf
    v_dot2c_f32_bf16_dpp v17, v5, v64 row_newbcast:6 row_mask:0xf bank_mask:0xf
    v_dot2c_f32_bf16_dpp v18, v4, v65 row_newbcast:6 row_mask:0xf bank_mask:0xf
    v_dot2c_f32_bf16_dpp v19, v5, v65 row_newbcast:6 row_mask:0xf bank_mask:0xf
    v_dot2c_f32_bf16_dpp v20, v4, v66 row_newbcast:6 row_mask:0xf bank_mask:0xf
    v_dot2c_f32_bf16_dpp v21, v5, v66 row_newbcast:6 row_mask:0xf bank_mask:0xf
    v_dot2c_f32_bf16_dpp v22, v4, v67 row_newbcast:6 row_mask:0xf bank_mask:0xf
    v_dot2c_f32_bf16_dpp v23, v5, v67 row_newbcast:6 row_mask:0xf bank_mask:0xf
    s_waitcnt vmcnt(3)
    buffer_load_dwordx4 v[64:67], v1, s[28:31], s51 offen offset:768 nt
    ds_add_u32 v36, v37 offset:6400
    ds_read_b32 v38, v36 offset:7424
    v_dot2c_f32_bf16_dpp v16, v4, v68 row_newbcast:7 row_mask:0xf bank_mask:0xf
    v_dot2c_f32_bf16_dpp v17, v5, v68 row_newbcast:7 row_mask:0xf bank_mask:0xf
    v_dot2c_f32_bf16_dpp v18, v4, v69 row_newbcast:7 row_mask:0xf bank_mask:0xf
    v_dot2c_f32_bf16_dpp v19, v5, v69 row_newbcast:7 row_mask:0xf bank_mask:0xf
    v_dot2c_f32_bf16_dpp v20, v4, v70 row_newbcast:7 row_mask:0xf bank_mask:0xf
    v_dot2c_f32_bf16_dpp v21, v5, v70 row_newbcast:7 row_mask:0xf bank_mask:0xf
    v_dot2c_f32_bf16_dpp v22, v4, v71 row_newbcast:7 row_mask:0xf bank_mask:0xf
    v_dot2c_f32_bf16_dpp v23, v5, v71 row_newbcast:7 row_mask:0xf bank_mask:0xf
    s_waitcnt vmcnt(3)
    buffer_load_dwordx4 v[68:71], v1, s[28:31], s36 offen offset:768 nt
    s_waitcnt lgkmcnt(0)
    v_readfirstlane_b32 s48, v38
    s_branch L_vj0
L_v1_0:
    v_dot2c_f32_bf16_dpp v16, v4, v72 row_newbcast:8 row_mask:0xf bank_mask:0xf
    v_dot2c_f32_bf16_dpp v17, v5, v72 row_newbcast:8 row_mask:0xf bank_mask:0xf
    v_dot2c_f32_bf16_dpp v18, v4, v73 row_newbcast:8 row_mask:0xf bank_mask:0xf
    v_dot2c_f32_bf16_dpp v19, v5, v73 row_newbcast:8 row_mask:0xf bank_mask:0xf
    v_dot2c_f32_bf16_dpp v20, v4, v74 row_newbcast:8 row_mask:0xf bank_mask:0xf
    v_dot2c_f32_bf16_dpp v21, v5, v74 row_newbcast:8 row_mask:0xf bank_mask:0xf
    v_dot2c_f32_bf16_dpp v22, v4, v75 row_newbcast:8 row_mask:0xf bank_mask:0xf
    v_dot2c_f32_bf16_dpp v23, v5, v75 row_newbcast:8 row_mask:0xf bank_mask:0xf
    s_waitcnt vmcnt(3)
    s_add_u32 s36, s51, 0x1000
    buffer_load_dwordx4 v[72:75], v1, s[28:31], s36 offen nt
    ds_add_u32 v36, v37 offset:6400
    v_dot2c_f32_bf16_dpp v16, v4, v76 row_newbcast:9 row_mask:0xf bank_mask:0xf
    v_dot2c_f32_bf16_dpp v17, v5, v76 row_newbcast:9 row_mask:0xf bank_mask:0xf
    v_dot2c_f32_bf16_dpp v18, v4, v77 row_newbcast:9 row_mask:0xf bank_mask:0xf
    v_dot2c_f32_bf16_dpp v19, v5, v77 row_newbcast:9 row_mask:0xf bank_mask:0xf
    v_dot2c_f32_bf16_dpp v20, v4, v78 row_newbcast:9 row_mask:0xf bank_mask:0xf
    v_dot2c_f32_bf16_dpp v21, v5, v78 row_newbcast:9 row_mask:0xf bank_mask:0xf
    v_dot2c_f32_bf16_dpp v22, v4, v79 row_newbcast:9 row_mask:0xf bank_mask:0xf
    v_dot2c_f32_bf16_dpp v23, v5, v79 row_newbcast:9 row_mask:0xf bank_mask:0xf
    s_waitcnt vmcnt(3)
    s_add_u32 s36, s51, 0x5000
    buffer_load_dwordx4 v[76:79], v1, s[28:31], s36 offen nt
    v_dot2c_f32_bf16_dpp v16, v4, v80 row_newbcast:10 row_mask:0xf bank_mask:0xf
    v_dot2c_f32_bf16_dpp v17, v5, v80 row_newbcast:10 row_mask:0xf bank_mask:0xf
    v_dot2c_f32_bf16_dpp v18, v4, v81 row_newbcast:10 row_mask:0xf bank_mask:0xf
    v_dot2c_f32_bf16_dpp v19, v5, v81 row_newbcast:10 row_mask:0xf bank_mask:0xf
    v_dot2c_f32_bf16_dpp v20, v4, v82 row_newbcast:10 row_mask:0xf bank_mask:0xf
    v_dot2c_f32_bf16_dpp v21, v5, v82 row_newbcast:10 row_mask:0xf bank_mask:0xf
    v_dot2c_f32_bf16_dpp v22, v4, v83 row_newbcast:10 row_mask:0xf bank_mask:0xf
    v_dot2c_f32_bf16_dpp v23, v5, v83 row_newbcast:10 row_mask:0xf bank_mask:0xf
    s_waitcnt vmcnt(3)
    s_add_u32 s36, s51, 0x1000
    buffer_load_dwordx4 v[80:83], v1, s[28:31], s36 offen offset:512 nt
    ds_add_u32 v36, v37 offset:6400
    v_dot2c_f32_bf16_dpp v16, v4, v84 row_newbcast:11 row_mask:0xf bank_mask:0xf
    v_dot2c_f32_bf16_dpp v17, v5, v84 row_newbcast:11 row_mask:0xf bank_mask:0xf
    v_dot2c_f32_bf16_dpp v18, v4, v85 row_newbcast:11 row_mask:0xf bank_mask:0xf
    v_dot2c_f32_bf16_dpp v19, v5, v85 row_newbcast:11 row_mask:0xf bank_mask:0xf
    v_dot2c_f32_bf16_dpp v20, v4, v86 row_newbcast:11 row_mask:0xf bank_mask:0xf
    v_dot2c_f32_bf16_dpp v21, v5, v86 row_newbcast:11 row_mask:0xf bank_mask:0xf
    v_dot2c_f32_bf16_dpp v22, v4, v87 row_newbcast:11 row_mask:0xf bank_mask:0xf
    v_dot2c_f32_bf16_dpp v23, v5, v87 row_newbcast:11 row_mask:0xf bank_mask:0xf
    s_waitcnt vmcnt(3)
    s_add_u32 s36, s51, 0x5000
    buffer_load_dwordx4 v[84:87], v1, s[28:31], s36 offen offset:512 nt
    v_dot2c_f32_bf16_dpp v16, v4, v88 row_newbcast:12 row_mask:0xf bank_mask:0xf
    v_dot2c_f32_bf16_dpp v17, v5, v88 row_newbcast:12 row_mask:0xf bank_mask:0xf
    v_dot2c_f32_bf16_dpp v18, v4, v89 row_newbcast:12 row_mask:0xf bank_mask:0xf
    v_dot2c_f32_bf16_dpp v19, v5, v89 row_newbcast:12 row_mask:0xf bank_mask:0xf
    v_dot2c_f32_bf16_dpp v20, v4, v90 row_newbcast:12 row_mask:0xf bank_mask:0xf
    v_dot2c_f32_bf16_dpp v21, v5, v90 row_newbcast:12 row_mask:0xf bank_mask:0xf
    v_dot2c_f32_bf16_dpp v22, v4, v91 row_newbcast:12 row_mask:0xf bank_mask:0xf
    v_dot2c_f32_bf16_dpp v23, v5, v91 row_newbcast:12 row_mask:0xf bank_mask:0xf
    s_waitcnt vmcnt(3)
    s_add_u32 s36, s51, 0x1000
    buffer_load_dwordx4 v[88:91], v1, s[28:31], s36 offen offset:256 nt
    ds_add_u32 v36, v37 offset:6400
    v_dot2c_f32_bf16_dpp v16, v4, v92 row_newbcast:13 row_mask:0xf bank_mask:0xf
    v_dot2c_f32_bf16_dpp v17, v5, v92 row_newbcast:13 row_mask:0xf bank_mask:0xf
    v_dot2c_f32_bf16_dpp v18, v4, v93 row_newbcast:13 row_mask:0xf bank_mask:0xf
    v_dot2c_f32_bf16_dpp v19, v5, v93 row_newbcast:13 row_mask:0xf bank_mask:0xf
    v_dot2c_f32_bf16_dpp v20, v4, v94 row_newbcast:13 row_mask:0xf bank_mask:0xf
    v_dot2c_f32_bf16_dpp v21, v5, v94 row_newbcast:13 row_mask:0xf bank_mask:0xf
    v_dot2c_f32_bf16_dpp v22, v4, v95 row_newbcast:13 row_mask:0xf bank_mask:0xf
    v_dot2c_f32_bf16_dpp v23, v5, v95 row_newbcast:13 row_mask:0xf bank_mask:0xf
    s_waitcnt vmcnt(3)
    s_add_u32 s36, s51, 0x5000
    buffer_load_dwordx4 v[92:95], v1, s[28:31], s36 offen offset:256 nt
    v_dot2c_f32_bf16_dpp v16, v4, v96 row_newbcast:14 row_mask:0xf bank_mask:0xf
    v_dot2c_f32_bf16_dpp v17, v5, v96 row_newbcast:14 row_mask:0xf bank_mask:0xf
    v_dot2c_f32_bf16_dpp v18, v4, v97 row_newbcast:14 row_mask:0xf bank_mask:0xf
    v_dot2c_f32_bf16_dpp v19, v5, v97 row_newbcast:14 row_mask:0xf bank_mask:0xf
    v_dot2c_f32_bf16_dpp v20, v4, v98 row_newbcast:14 row_mask:0xf bank_mask:0xf
    v_dot2c_f32_bf16_dpp v21, v5, v98 row_newbcast:14 row_mask:0xf bank_mask:0xf
    v_dot2c_f32_bf16_dpp v22, v4, v99 row_newbcast:14 row_mask:0xf bank_mask:0xf
    v_dot2c_f32_bf16_dpp v23, v5, v99 row_newbcast:14 row_mask:0xf bank_mask:0xf
    s_waitcnt vmcnt(3)
    s_add_u32 s36, s51, 0x1000
    buffer_load_dwordx4 v[96:99], v1, s[28:31], s36 offen offset:768 nt
    ds_add_u32 v36, v37 offset:6400
    ds_read_b32 v38, v36 offset:7424
    v_dot2c_f32_bf16_dpp v16, v4, v100 row_newbcast:15 row_mask:0xf bank_mask:0xf
    v_dot2c_f32_bf16_dpp v17, v5, v100 row_newbcast:15 row_mask:0xf bank_mask:0xf
    v_dot2c_f32_bf16_dpp v18, v4, v101 row_newbcast:15 row_mask:0xf bank_mask:0xf
    v_dot2c_f32_bf16_dpp v19, v5, v101 row_newbcast:15 row_mask:0xf bank_mask:0xf
    v_dot2c_f32_bf16_dpp v20, v4, v102 row_newbcast:15 row_mask:0xf bank_mask:0xf
    v_dot2c_f32_bf16_dpp v21, v5, v102 row_newbcast:15 row_mask:0xf bank_mask:0xf
    v_dot2c_f32_bf16_dpp v22, v4, v103 row_newbcast:15 row_mask:0xf bank_mask:0xf
    v_dot2c_f32_bf16_dpp v23, v5, v103 row_newbcast:15 row_mask:0xf bank_mask:0xf
    s_waitcnt vmcnt(3)
    s_add_u32 s36, s51, 0x5000
    buffer_load_dwordx4 v[100:103], v1, s[28:31], s36 offen offset:768 nt
    s_waitcnt lgkmcnt(0)
    v_readfirstlane_b32 s48, v38
    s_branch L_vj1
L_v0_2:
    v_dot2c_f32_bf16_dpp v16, v4, v40 row_newbcast:0 row_mask:0xf bank_mask:0xf
    v_dot2c_f32_bf16_dpp v17, v5, v40 row_newbcast:0 row_mask:0xf bank_mask:0xf
    v_dot2c_f32_bf16_dpp v18, v4, v41 row_newbcast:0 row_mask:0xf bank_mask:0xf
    v_dot2c_f32_bf16_dpp v19, v5, v41 row_newbcast:0 row_mask:0xf bank_mask:0xf
    v_dot2c_f32_bf16_dpp v20, v4, v42 row_newbcast:0 row_mask:0xf bank_mask:0xf
    v_dot2c_f32_bf16_dpp v21, v5, v42 row_newbcast:0 row_mask:0xf bank_mask:0xf
    v_dot2c_f32_bf16_dpp v22, v4, v43 row_newbcast:0 row_mask:0xf bank_mask:0xf
    v_dot2c_f32_bf16_dpp v23, v5, v43 row_newbcast:0 row_mask:0xf bank_mask:0xf
    s_waitcnt vmcnt(5)
    buffer_load_dwordx4 v[40:43], v1, s[28:31], s51 offen nt
    ds_add_u32 v36, v37 offset:6400
    v_dot2c_f32_bf16_dpp v16, v4, v44 row_newbcast:1 row_mask:0xf bank_mask:0xf
    v_dot2c_f32_bf16_dpp v17, v5, v44 row_newbcast:1 row_mask:0xf bank_mask:0xf
    v_dot2c_f32_bf16_dpp v18, v4, v45 row_newbcast:1 row_mask:0xf bank_mask:0xf
    v_dot2c_f32_bf16_dpp v19, v5, v45 row_newbcast:1 row_mask:0xf bank_mask:0xf
    v_dot2c_f32_bf16_dpp v20, v4, v46 row_newbcast:1 row_mask:0xf bank_mask:0xf
    v_dot2c_f32_bf16_dpp v21, v5, v46 row_newbcast:1 row_mask:0xf bank_mask:0xf
    v_dot2c_f32_bf16_dpp v22, v4, v47 row_newbcast:1 row_mask:0xf bank_mask:0xf
    v_dot2c_f32_bf16_dpp v23, v5, v47 row_newbcast:1 row_mask:0xf bank_mask:0xf
    s_waitcnt vmcnt(5)
    s_add_u32 s36, s51, 0x4000
    buffer_load_dwordx4 v[44:47], v1, s[28:31], s36 offen nt
    v_dot2c_f32_bf16_dpp v16, v4, v48 row_newbcast:2 row_mask:0xf bank_mask:0xf
    v_dot2c_f32_bf16_dpp v17, v5, v48 row_newbcast:2 row_mask:0xf bank_mask:0xf
    v_dot2c_f32_bf16_dpp v18, v4, v49 row_newbcast:2 row_mask:0xf bank_mask:0xf
    v_dot2c_f32_bf16_dpp v19, v5, v49 row_newbcast:2 row_mask:0xf bank_mask:0xf
    v_dot2c_f32_bf16_dpp v20, v4, v50 row_newbcast:2 row_mask:0xf bank_mask:0xf
    v_dot2c_f32_bf16_dpp v21, v5, v50 row_newbcast:2 row_mask:0xf bank_mask:0xf
    v_dot2c_f32_bf16_dpp v22, v4, v51 row_newbcast:2 row_mask:0xf bank_mask:0xf
    v_dot2c_f32_bf16_dpp v23, v5, v51 row_newbcast:2 row_mask:0xf bank_mask:0xf
    s_waitcnt vmcnt(5)
    buffer_load_dwordx4 v[48:51], v1, s[28:31], s51 offen offset:512 nt
    ds_add_u32 v36, v37 offset:6400
    v_dot2c_f32_bf16_dpp v16, v4, v52 row_newbcast:3 row_mask:0xf bank_mask:0xf
    v_dot2c_f32_bf16_dpp v17, v5, v52 row_newbcast:3 row_mask:0xf bank_mask:0xf
    v_dot2c_f32_bf16_dpp v18, v4, v53 row_newbcast:3 row_mask:0xf bank_mask:0xf
    v_dot2c_f32_bf16_dpp v19, v5, v53 row_newbcast:3 row_mask:0xf bank_mask:0xf
    v_dot2c_f32_bf16_dpp v20, v4, v54 row_newbcast:3 row_mask:0xf bank_mask:0xf
    v_dot2c_f32_bf16_dpp v21, v5, v54 row_newbcast:3 row_mask:0xf bank_mask:0xf
    v_dot2c_f32_bf16_dpp v22, v4, v55 row_newbcast:3 row_mask:0xf bank_mask:0xf
    v_dot2c_f32_bf16_dpp v23, v5, v55 row_newbcast:3 row_mask:0xf bank_mask:0xf
    s_waitcnt vmcnt(5)
    buffer_load_dwordx4 v[52:55], v1, s[28:31], s36 offen offset:512 nt
    v_dot2c_f32_bf16_dpp v16, v4, v56 row_newbcast:4 row_mask:0xf bank_mask:0xf
    v_dot2c_f32_bf16_dpp v17, v5, v56 row_newbcast:4 row_mask:0xf bank_mask:0xf
    v_dot2c_f32_bf16_dpp v18, v4, v57 row_newbcast:4 row_mask:0xf bank_mask:0xf
    v_dot2c_f32_bf16_dpp v19, v5, v57 row_newbcast:4 row_mask:0xf bank_mask:0xf
    v_dot2c_f32_bf16_dpp v20, v4, v58 row_newbcast:4 row_mask:0xf bank_mask:0xf
    v_dot2c_f32_bf16_dpp v21, v5, v58 row_newbcast:4 row_mask:0xf bank_mask:0xf
    v_dot2c_f32_bf16_dpp v22, v4, v59 row_newbcast:4 row_mask:0xf bank_mask:0xf
    v_dot2c_f32_bf16_dpp v23, v5, v59 row_newbcast:4 row_mask:0xf bank_mask:0xf
    s_waitcnt vmcnt(5)
    buffer_load_dwordx4 v[56:59], v1, s[28:31], s51 offen offset:256 nt
    ds_add_u32 v36, v37 offset:6400
    v_dot2c_f32_bf16_dpp v16, v4, v60 row_newbcast:5 row_mask:0xf bank_mask:0xf
    v_dot2c_f32_bf16_dpp v17, v5, v60 row_newbcast:5 row_mask:0xf bank_mask:0xf
    v_dot2c_f32_bf16_dpp v18, v4, v61 row_newbcast:5 row_mask:0xf bank_mask:0xf
    v_dot2c_f32_bf16_dpp v19, v5, v61 row_newbcast:5 row_mask:0xf bank_mask:0xf
    v_dot2c_f32_bf16_dpp v20, v4, v62 row_newbcast:5 row_mask:0xf bank_mask:0xf
    v_dot2c_f32_bf16_dpp v21, v5, v62 row_newbcast:5 row_mask:0xf bank_mask:0xf
    v_dot2c_f32_bf16_dpp v22, v4, v63 row_newbcast:5 row_mask:0xf bank_mask:0xf
    v_dot2c_f32_bf16_dpp v23, v5, v63 row_newbcast:5 row_mask:0xf bank_mask:0xf
    s_waitcnt vmcnt(5)
    buffer_load_dwordx4 v[60:63], v1, s[28:31], s36 offen offset:256 nt
    v_dot2c_f32_bf16_dpp v16, v4, v64 row_newbcast:6 row_mask:0xf bank_mask:0xf
    v_dot2c_f32_bf16_dpp v17, v5, v64 row_newbcast:6 row_mask:0xf bank_mask:0xf
    v_dot2c_f32_bf16_dpp v18, v4, v65 row_newbcast:6 row_mask:0xf bank_mask:0xf
    v_dot2c_f32_bf16_dpp v19, v5, v65 row_newbcast:6 row_mask:0xf bank_mask:0xf
    v_dot2c_f32_bf16_dpp v20, v4, v66 row_newbcast:6 row_mask:0xf bank_mask:0xf
    v_dot2c_f32_bf16_dpp v21, v5, v66 row_newbcast:6 row_mask:0xf bank_mask:0xf
    v_dot2c_f32_bf16_dpp v22, v4, v67 row_newbcast:6 row_mask:0xf bank_mask:0xf
    v_dot2c_f32_bf16_dpp v23, v5, v67 row_newbcast:6 row_mask:0xf bank_mask:0xf
    s_waitcnt vmcnt(5)
    buffer_load_dwordx4 v[64:67], v1, s[28:31], s51 offen offset:768 nt
    ds_add_u32 v36, v37 offset:6400
    ds_read_b32 v38, v36 offset:7424
    v_dot2c_f32_bf16_dpp v16, v4, v68 row_newbcast:7 row_mask:0xf bank_mask:0xf
    v_dot2c_f32_bf16_dpp v17, v5, v68 row_newbcast:7 row_mask:0xf bank_mask:0xf
    v_dot2c_f32_bf16_dpp v18, v4, v69 row_newbcast:7 row_mask:0xf bank_mask:0xf
    v_dot2c_f32_bf16_dpp v19, v5, v69 row_newbcast:7 row_mask:0xf bank_mask:0xf
    v_dot2c_f32_bf16_dpp v20, v4, v70 row_newbcast:7 row_mask:0xf bank_mask:0xf
    v_dot2c_f32_bf16_dpp v21, v5, v70 row_newbcast:7 row_mask:0xf bank_mask:0xf
    v_dot2c_f32_bf16_dpp v22, v4, v71 row_newbcast:7 row_mask:0xf bank_mask:0xf
    v_dot2c_f32_bf16_dpp v23, v5, v71 row_newbcast:7 row_mask:0xf bank_mask:0xf
    s_waitcnt vmcnt(5)
    buffer_load_dwordx4 v[68:71], v1, s[28:31], s36 offen offset:768 nt
    s_waitcnt lgkmcnt(0)
    v_readfirstlane_b32 s48, v38
    s_branch L_vj0
L_v1_2:
    v_dot2c_f32_bf16_dpp v16, v4, v72 row_newbcast:8 row_mask:0xf bank_mask:0xf
    v_dot2c_f32_bf16_dpp v17, v5, v72 row_newbcast:8 row_mask:0xf bank_mask:0xf
    v_dot2c_f32_bf16_dpp v18, v4, v73 row_newbcast:8 row_mask:0xf bank_mask:0xf
    v_dot2c_f32_bf16_dpp v19, v5, v73 row_newbcast:8 row_mask:0xf bank_mask:0xf
    v_dot2c_f32_bf16_dpp v20, v4, v74 row_newbcast:8 row_mask:0xf bank_mask:0xf
    v_dot2c_f32_bf16_dpp v21, v5, v74 row_newbcast:8 row_mask:0xf bank_mask:0xf
    v_dot2c_f32_bf16_dpp v22, v4, v75 row_newbcast:8 row_mask:0xf bank_mask:0xf
    v_dot2c_f32_bf16_dpp v23, v5, v75 row_newbcast:8 row_mask:0xf bank_mask:0xf
    s_waitcnt vmcnt(5)
    s_add_u32 s36, s51, 0x1000
    buffer_load_dwordx4 v[72:75], v1, s[28:31], s36 offen nt
    ds_add_u32 v36, v37 offset:6400
    v_dot2c_f32_bf16_dpp v16, v4, v76 row_newbcast:9 row_mask:0xf bank_mask:0xf
    v_dot2c_f32_bf16_dpp v17, v5, v76 row_newbcast:9 row_mask:0xf bank_mask:0xf
    v_dot2c_f32_bf16_dpp v18, v4, v77 row_newbcast:9 row_mask:0xf bank_mask:0xf
    v_dot2c_f32_bf16_dpp v19, v5, v77 row_newbcast:9 row_mask:0xf bank_mask:0xf
    v_dot2c_f32_bf16_dpp v20, v4, v78 row_newbcast:9 row_mask:0xf bank_mask:0xf
    v_dot2c_f32_bf16_dpp v21, v5, v78 row_newbcast:9 row_mask:0xf bank_mask:0xf
    v_dot2c_f32_bf16_dpp v22, v4, v79 row_newbcast:9 row_mask:0xf bank_mask:0xf
    v_dot2c_f32_bf16_dpp v23, v5, v79 row_newbcast:9 row_mask:0xf bank_mask:0xf
    s_waitcnt vmcnt(5)
    s_add_u32 s36, s51, 0x5000
    buffer_load_dwordx4 v[76:79], v1, s[28:31], s36 offen nt
    v_dot2c_f32_bf16_dpp v16, v4, v80 row_newbcast:10 row_mask:0xf bank_mask:0xf
    v_dot2c_f32_bf16_dpp v17, v5, v80 row_newbcast:10 row_mask:0xf bank_mask:0xf
    v_dot2c_f32_bf16_dpp v18, v4, v81 row_newbcast:10 row_mask:0xf bank_mask:0xf
    v_dot2c_f32_bf16_dpp v19, v5, v81 row_newbcast:10 row_mask:0xf bank_mask:0xf
    v_dot2c_f32_bf16_dpp v20, v4, v82 row_newbcast:10 row_mask:0xf bank_mask:0xf
    v_dot2c_f32_bf16_dpp v21, v5, v82 row_newbcast:10 row_mask:0xf bank_mask:0xf
    v_dot2c_f32_bf16_dpp v22, v4, v83 row_newbcast:10 row_mask:0xf bank_mask:0xf
    v_dot2c_f32_bf16_dpp v23, v5, v83 row_newbcast:10 row_mask:0xf bank_mask:0xf
    s_waitcnt vmcnt(5)
    s_add_u32 s36, s51, 0x1000
    buffer_load_dwordx4 v[80:83], v1, s[28:31], s36 offen offset:512 nt
    ds_add_u32 v36, v37 offset:6400
    v_dot2c_f32_bf16_dpp v16, v4, v84 row_newbcast:11 row_mask:0xf bank_mask:0xf
    v_dot2c_f32_bf16_dpp v17, v5, v84 row_newbcast:11 row_mask:0xf bank_mask:0xf
    v_dot2c_f32_bf16_dpp v18, v4, v85 row_newbcast:11 row_mask:0xf bank_mask:0xf
    v_dot2c_f32_bf16_dpp v19, v5, v85 row_newbcast:11 row_mask:0xf bank_mask:0xf
    v_dot2c_f32_bf16_dpp v20, v4, v86 row_newbcast:11 row_mask:0xf bank_mask:0xf
    v_dot2c_f32_bf16_dpp v21, v5, v86 row_newbcast:11 row_mask:0xf bank_mask:0xf
    v_dot2c_f32_bf16_dpp v22, v4, v87 row_newbcast:11 row_mask:0xf bank_mask:0xf
    v_dot2c_f32_bf16_dpp v23, v5, v87 row_newbcast:11 row_mask:0xf bank_mask:0xf
    s_waitcnt vmcnt(5)
    s_add_u32 s36, s51, 0x5000
    buffer_load_dwordx4 v[84:87], v1, s[28:31], s36 offen offset:512 nt
    v_dot2c_f32_bf16_dpp v16, v4, v88 row_newbcast:12 row_mask:0xf bank_mask:0xf
    v_dot2c_f32_bf16_dpp v17, v5, v88 row_newbcast:12 row_mask:0xf bank_mask:0xf
    v_dot2c_f32_bf16_dpp v18, v4, v89 row_newbcast:12 row_mask:0xf bank_mask:0xf
    v_dot2c_f32_bf16_dpp v19, v5, v89 row_newbcast:12 row_mask:0xf bank_mask:0xf
    v_dot2c_f32_bf16_dpp v20, v4, v90 row_newbcast:12 row_mask:0xf bank_mask:0xf
    v_dot2c_f32_bf16_dpp v21, v5, v90 row_newbcast:12 row_mask:0xf bank_mask:0xf
    v_dot2c_f32_bf16_dpp v22, v4, v91 row_newbcast:12 row_mask:0xf bank_mask:0xf
    v_dot2c_f32_bf16_dpp v23, v5, v91 row_newbcast:12 row_mask:0xf bank_mask:0xf
    s_waitcnt vmcnt(5)
    s_add_u32 s36, s51, 0x1000
    buffer_load_dwordx4 v[88:91], v1, s[28:31], s36 offen offset:256 nt
    ds_add_u32 v36, v37 offset:6400
    v_dot2c_f32_bf16_dpp v16, v4, v92 row_newbcast:13 row_mask:0xf bank_mask:0xf
    v_dot2c_f32_bf16_dpp v17, v5, v92 row_newbcast:13 row_mask:0xf bank_mask:0xf
    v_dot2c_f32_bf16_dpp v18, v4, v93 row_newbcast:13 row_mask:0xf bank_mask:0xf
    v_dot2c_f32_bf16_dpp v19, v5, v93 row_newbcast:13 row_mask:0xf bank_mask:0xf
    v_dot2c_f32_bf16_dpp v20, v4, v94 row_newbcast:13 row_mask:0xf bank_mask:0xf
    v_dot2c_f32_bf16_dpp v21, v5, v94 row_newbcast:13 row_mask:0xf bank_mask:0xf
    v_dot2c_f32_bf16_dpp v22, v4, v95 row_newbcast:13 row_mask:0xf bank_mask:0xf
    v_dot2c_f32_bf16_dpp v23, v5, v95 row_newbcast:13 row_mask:0xf bank_mask:0xf
    s_waitcnt vmcnt(5)
    s_add_u32 s36, s51, 0x5000
    buffer_load_dwordx4 v[92:95], v1, s[28:31], s36 offen offset:256 nt
    v_dot2c_f32_bf16_dpp v16, v4, v96 row_newbcast:14 row_mask:0xf bank_mask:0xf
    v_dot2c_f32_bf16_dpp v17, v5, v96 row_newbcast:14 row_mask:0xf bank_mask:0xf
    v_dot2c_f32_bf16_dpp v18, v4, v97 row_newbcast:14 row_mask:0xf bank_mask:0xf
    v_dot2c_f32_bf16_dpp v19, v5, v97 row_newbcast:14 row_mask:0xf bank_mask:0xf
    v_dot2c_f32_bf16_dpp v20, v4, v98 row_newbcast:14 row_mask:0xf bank_mask:0xf
    v_dot2c_f32_bf16_dpp v21, v5, v98 row_newbcast:14 row_mask:0xf bank_mask:0xf
    v_dot2c_f32_bf16_dpp v22, v4, v99 row_newbcast:14 row_mask:0xf bank_mask:0xf
    v_dot2c_f32_bf16_dpp v23, v5, v99 row_newbcast:14 row_mask:0xf bank_mask:0xf
    s_waitcnt vmcnt(5)
    s_add_u32 s36, s51, 0x1000
    buffer_load_dwordx4 v[96:99], v1, s[28:31], s36 offen offset:768 nt
    ds_add_u32 v36, v37 offset:6400
    ds_read_b32 v38, v36 offset:7424
    v_dot2c_f32_bf16_dpp v16, v4, v100 row_newbcast:15 row_mask:0xf bank_mask:0xf
    v_dot2c_f32_bf16_dpp v17, v5, v100 row_newbcast:15 row_mask:0xf bank_mask:0xf
    v_dot2c_f32_bf16_dpp v18, v4, v101 row_newbcast:15 row_mask:0xf bank_mask:0xf
    v_dot2c_f32_bf16_dpp v19, v5, v101 row_newbcast:15 row_mask:0xf bank_mask:0xf
    v_dot2c_f32_bf16_dpp v20, v4, v102 row_newbcast:15 row_mask:0xf bank_mask:0xf
    v_dot2c_f32_bf16_dpp v21, v5, v102 row_newbcast:15 row_mask:0xf bank_mask:0xf
    v_dot2c_f32_bf16_dpp v22, v4, v103 row_newbcast:15 row_mask:0xf bank_mask:0xf
    v_dot2c_f32_bf16_dpp v23, v5, v103 row_newbcast:15 row_mask:0xf bank_mask:0xf
    s_waitcnt vmcnt(5)
    s_add_u32 s36, s51, 0x5000
    buffer_load_dwordx4 v[100:103], v1, s[28:31], s36 offen offset:768 nt
    s_waitcnt lgkmcnt(0)
    v_readfirstlane_b32 s48, v38
    s_branch L_vj1
L_v0_3:
    v_dot2c_f32_bf16_dpp v16, v4, v40 row_newbcast:0 row_mask:0xf bank_mask:0xf
    v_dot2c_f32_bf16_dpp v17, v5, v40 row_newbcast:0 row_mask:0xf bank_mask:0xf
    v_dot2c_f32_bf16_dpp v18, v4, v41 row_newbcast:0 row_mask:0xf bank_mask:0xf
    v_dot2c_f32_bf16_dpp v19, v5, v41 row_newbcast:0 row_mask:0xf bank_mask:0xf
    v_dot2c_f32_bf16_dpp v20, v4, v42 row_newbcast:0 row_mask:0xf bank_mask:0xf
    v_dot2c_f32_bf16_dpp v21, v5, v42 row_newbcast:0 row_mask:0xf bank_mask:0xf
    v_dot2c_f32_bf16_dpp v22, v4, v43 row_newbcast:0 row_mask:0xf bank_mask:0xf
    v_dot2c_f32_bf16_dpp v23, v5, v43 row_newbcast:0 row_mask:0xf bank_mask:0xf
    s_waitcnt vmcnt(6)
    buffer_load_dwordx4 v[40:43], v1, s[28:31], s51 offen nt
    ds_add_u32 v36, v37 offset:6400
    v_dot2c_f32_bf16_dpp v16, v4, v44 row_newbcast:1 row_mask:0xf bank_mask:0xf
    v_dot2c_f32_bf16_dpp v17, v5, v44 row_newbcast:1 row_mask:0xf bank_mask:0xf
    v_dot2c_f32_bf16_dpp v18, v4, v45 row_newbcast:1 row_mask:0xf bank_mask:0xf
    v_dot2c_f32_bf16_dpp v19, v5, v45 row_newbcast:1 row_mask:0xf bank_mask:0xf
    v_dot2c_f32_bf16_dpp v20, v4, v46 row_newbcast:1 row_mask:0xf bank_mask:0xf
    v_dot2c_f32_bf16_dpp v21, v5, v46 row_newbcast:1 row_mask:0xf bank_mask:0xf
    v_dot2c_f32_bf16_dpp v22, v4, v47 row_newbcast:1 row_mask:0xf bank_mask:0xf
    v_dot2c_f32_bf16_dpp v23, v5, v47 row_newbcast:1 row_mask:0xf bank_mask:0xf
    s_waitcnt vmcnt(6)
    s_add_u32 s36, s51, 0x4000
    buffer_load_dwordx4 v[44:47], v1, s[28:31], s36 offen nt
    v_dot2c_f32_bf16_dpp v16, v4, v48 row_newbcast:2 row_mask:0xf bank_mask:0xf
    v_dot2c_f32_bf16_dpp v17, v5, v48 row_newbcast:2 row_mask:0xf bank_mask:0xf
    v_dot2c_f32_bf16_dpp v18, v4, v49 row_newbcast:2 row_mask:0xf bank_mask:0xf
    v_dot2c_f32_bf16_dpp v19, v5, v49 row_newbcast:2 row_mask:0xf bank_mask:0xf
    v_dot2c_f32_bf16_dpp v20, v4, v50 row_newbcast:2 row_mask:0xf bank_mask:0xf
    v_dot2c_f32_bf16_dpp v21, v5, v50 row_newbcast:2 row_mask:0xf bank_mask:0xf
    v_dot2c_f32_bf16_dpp v22, v4, v51 row_newbcast:2 row_mask:0xf bank_mask:0xf
    v_dot2c_f32_bf16_dpp v23, v5, v51 row_newbcast:2 row_mask:0xf bank_mask:0xf
    s_waitcnt vmcnt(6)
    buffer_load_dwordx4 v[48:51], v1, s[28:31], s51 offen offset:512 nt
    ds_add_u32 v36, v37 offset:6400
    v_dot2c_f32_bf16_dpp v16, v4, v52 row_newbcast:3 row_mask:0xf bank_mask:0xf
    v_dot2c_f32_bf16_dpp v17, v5, v52 row_newbcast:3 row_mask:0xf bank_mask:0xf
    v_dot2c_f32_bf16_dpp v18, v4, v53 row_newbcast:3 row_mask:0xf bank_mask:0xf
    v_dot2c_f32_bf16_dpp v19, v5, v53 row_newbcast:3 row_mask:0xf bank_mask:0xf
    v_dot2c_f32_bf16_dpp v20, v4, v54 row_newbcast:3 row_mask:0xf bank_mask:0xf
    v_dot2c_f32_bf16_dpp v21, v5, v54 row_newbcast:3 row_mask:0xf bank_mask:0xf
    v_dot2c_f32_bf16_dpp v22, v4, v55 row_newbcast:3 row_mask:0xf bank_mask:0xf
    v_dot2c_f32_bf16_dpp v23, v5, v55 row_newbcast:3 row_mask:0xf bank_mask:0xf
    s_waitcnt vmcnt(6)
    buffer_load_dwordx4 v[52:55], v1, s[28:31], s36 offen offset:512 nt
    v_dot2c_f32_bf16_dpp v16, v4, v56 row_newbcast:4 row_mask:0xf bank_mask:0xf
    v_dot2c_f32_bf16_dpp v17, v5, v56 row_newbcast:4 row_mask:0xf bank_mask:0xf
    v_dot2c_f32_bf16_dpp v18, v4, v57 row_newbcast:4 row_mask:0xf bank_mask:0xf
    v_dot2c_f32_bf16_dpp v19, v5, v57 row_newbcast:4 row_mask:0xf bank_mask:0xf
    v_dot2c_f32_bf16_dpp v20, v4, v58 row_newbcast:4 row_mask:0xf bank_mask:0xf
    v_dot2c_f32_bf16_dpp v21, v5, v58 row_newbcast:4 row_mask:0xf bank_mask:0xf
    v_dot2c_f32_bf16_dpp v22, v4, v59 row_newbcast:4 row_mask:0xf bank_mask:0xf
    v_dot2c_f32_bf16_dpp v23, v5, v59 row_newbcast:4 row_mask:0xf bank_mask:0xf
    s_waitcnt vmcnt(6)
    buffer_load_dwordx4 v[56:59], v1, s[28:31], s51 offen offset:256 nt
    ds_add_u32 v36, v37 offset:6400
    v_dot2c_f32_bf16_dpp v16, v4, v60 row_newbcast:5 row_mask:0xf bank_mask:0xf
    v_dot2c_f32_bf16_dpp v17, v5, v60 row_newbcast:5 row_mask:0xf bank_mask:0xf
    v_dot2c_f32_bf16_dpp v18, v4, v61 row_newbcast:5 row_mask:0xf bank_mask:0xf
    v_dot2c_f32_bf16_dpp v19, v5, v61 row_newbcast:5 row_mask:0xf bank_mask:0xf
    v_dot2c_f32_bf16_dpp v20, v4, v62 row_newbcast:5 row_mask:0xf bank_mask:0xf
    v_dot2c_f32_bf16_dpp v21, v5, v62 row_newbcast:5 row_mask:0xf bank_mask:0xf
    v_dot2c_f32_bf16_dpp v22, v4, v63 row_newbcast:5 row_mask:0xf bank_mask:0xf
    v_dot2c_f32_bf16_dpp v23, v5, v63 row_newbcast:5 row_mask:0xf bank_mask:0xf
    s_waitcnt vmcnt(6)
    buffer_load_dwordx4 v[60:63], v1, s[28:31], s36 offen offset:256 nt
    v_dot2c_f32_bf16_dpp v16, v4, v64 row_newbcast:6 row_mask:0xf bank_mask:0xf
    v_dot2c_f32_bf16_dpp v17, v5, v64 row_newbcast:6 row_mask:0xf bank_mask:0xf
    v_dot2c_f32_bf16_dpp v18, v4, v65 row_newbcast:6 row_mask:0xf bank_mask:0xf
    v_dot2c_f32_bf16_dpp v19, v5, v65 row_newbcast:6 row_mask:0xf bank_mask:0xf
    v_dot2c_f32_bf16_dpp v20, v4, v66 row_newbcast:6 row_mask:0xf bank_mask:0xf
    v_dot2c_f32_bf16_dpp v21, v5, v66 row_newbcast:6 row_mask:0xf bank_mask:0xf
    v_dot2c_f32_bf16_dpp v22, v4, v67 row_newbcast:6 row_mask:0xf bank_mask:0xf
    v_dot2c_f32_bf16_dpp v23, v5, v67 row_newbcast:6 row_mask:0xf bank_mask:0xf
    s_waitcnt vmcnt(6)
    buffer_load_dwordx4 v[64:67], v1, s[28:31], s51 offen offset:768 nt
    ds_add_u32 v36, v37 offset:6400
    ds_read_b32 v38, v36 offset:7424
    v_dot2c_f32_bf16_dpp v16, v4, v68 row_newbcast:7 row_mask:0xf bank_mask:0xf
    v_dot2c_f32_bf16_dpp v17, v5, v68 row_newbcast:7 row_mask:0xf bank_mask:0xf
    v_dot2c_f32_bf16_dpp v18, v4, v69 row_newbcast:7 row_mask:0xf bank_mask:0xf
    v_dot2c_f32_bf16_dpp v19, v5, v69 row_newbcast:7 row_mask:0xf bank_mask:0xf
    v_dot2c_f32_bf16_dpp v20, v4, v70 row_newbcast:7 row_mask:0xf bank_mask:0xf
    v_dot2c_f32_bf16_dpp v21, v5, v70 row_newbcast:7 row_mask:0xf bank_mask:0xf
    v_dot2c_f32_bf16_dpp v22, v4, v71 row_newbcast:7 row_mask:0xf bank_mask:0xf
    v_dot2c_f32_bf16_dpp v23, v5, v71 row_newbcast:7 row_mask:0xf bank_mask:0xf
    s_waitcnt vmcnt(6)
    buffer_load_dwordx4 v[68:71], v1, s[28:31], s36 offen offset:768 nt
    s_waitcnt lgkmcnt(0)
    v_readfirstlane_b32 s48, v38
    s_branch L_vj0
L_v1_3:
    v_dot2c_f32_bf16_dpp v16, v4, v72 row_newbcast:8 row_mask:0xf bank_mask:0xf
    v_dot2c_f32_bf16_dpp v17, v5, v72 row_newbcast:8 row_mask:0xf bank_mask:0xf
    v_dot2c_f32_bf16_dpp v18, v4, v73 row_newbcast:8 row_mask:0xf bank_mask:0xf
    v_dot2c_f32_bf16_dpp v19, v5, v73 row_newbcast:8 row_mask:0xf bank_mask:0xf
    v_dot2c_f32_bf16_dpp v20, v4, v74 row_newbcast:8 row_mask:0xf bank_mask:0xf
    v_dot2c_f32_bf16_dpp v21, v5, v74 row_newbcast:8 row_mask:0xf bank_mask:0xf
    v_dot2c_f32_bf16_dpp v22, v4, v75 row_newbcast:8 row_mask:0xf bank_mask:0xf
    v_dot2c_f32_bf16_dpp v23, v5, v75 row_newbcast:8 row_mask:0xf bank_mask:0xf
    s_waitcnt vmcnt(6)
    s_add_u32 s36, s51, 0x1000
    buffer_load_dwordx4 v[72:75], v1, s[28:31], s36 offen nt
    ds_add_u32 v36, v37 offset:6400
    v_dot2c_f32_bf16_dpp v16, v4, v76 row_newbcast:9 row_mask:0xf bank_mask:0xf
    v_dot2c_f32_bf16_dpp v17, v5, v76 row_newbcast:9 row_mask:0xf bank_mask:0xf
    v_dot2c_f32_bf16_dpp v18, v4, v77 row_newbcast:9 row_mask:0xf bank_mask:0xf
    v_dot2c_f32_bf16_dpp v19, v5, v77 row_newbcast:9 row_mask:0xf bank_mask:0xf
    v_dot2c_f32_bf16_dpp v20, v4, v78 row_newbcast:9 row_mask:0xf bank_mask:0xf
    v_dot2c_f32_bf16_dpp v21, v5, v78 row_newbcast:9 row_mask:0xf bank_mask:0xf
    v_dot2c_f32_bf16_dpp v22, v4, v79 row_newbcast:9 row_mask:0xf bank_mask:0xf
    v_dot2c_f32_bf16_dpp v23, v5, v79 row_newbcast:9 row_mask:0xf bank_mask:0xf
    s_waitcnt vmcnt(6)
    s_add_u32 s36, s51, 0x5000
    buffer_load_dwordx4 v[76:79], v1, s[28:31], s36 offen nt
    v_dot2c_f32_bf16_dpp v16, v4, v80 row_newbcast:10 row_mask:0xf bank_mask:0xf
    v_dot2c_f32_bf16_dpp v17, v5, v80 row_newbcast:10 row_mask:0xf bank_mask:0xf
    v_dot2c_f32_bf16_dpp v18, v4, v81 row_newbcast:10 row_mask:0xf bank_mask:0xf
    v_dot2c_f32_bf16_dpp v19, v5, v81 row_newbcast:10 row_mask:0xf bank_mask:0xf
    v_dot2c_f32_bf16_dpp v20, v4, v82 row_newbcast:10 row_mask:0xf bank_mask:0xf
    v_dot2c_f32_bf16_dpp v21, v5, v82 row_newbcast:10 row_mask:0xf bank_mask:0xf
    v_dot2c_f32_bf16_dpp v22, v4, v83 row_newbcast:10 row_mask:0xf bank_mask:0xf
    v_dot2c_f32_bf16_dpp v23, v5, v83 row_newbcast:10 row_mask:0xf bank_mask:0xf
    s_waitcnt vmcnt(6)
    s_add_u32 s36, s51, 0x1000
    buffer_load_dwordx4 v[80:83], v1, s[28:31], s36 offen offset:512 nt
    ds_add_u32 v36, v37 offset:6400
    v_dot2c_f32_bf16_dpp v16, v4, v84 row_newbcast:11 row_mask:0xf bank_mask:0xf
    v_dot2c_f32_bf16_dpp v17, v5, v84 row_newbcast:11 row_mask:0xf bank_mask:0xf
    v_dot2c_f32_bf16_dpp v18, v4, v85 row_newbcast:11 row_mask:0xf bank_mask:0xf
    v_dot2c_f32_bf16_dpp v19, v5, v85 row_newbcast:11 row_mask:0xf bank_mask:0xf
    v_dot2c_f32_bf16_dpp v20, v4, v86 row_newbcast:11 row_mask:0xf bank_mask:0xf
    v_dot2c_f32_bf16_dpp v21, v5, v86 row_newbcast:11 row_mask:0xf bank_mask:0xf
    v_dot2c_f32_bf16_dpp v22, v4, v87 row_newbcast:11 row_mask:0xf bank_mask:0xf
    v_dot2c_f32_bf16_dpp v23, v5, v87 row_newbcast:11 row_mask:0xf bank_mask:0xf
    s_waitcnt vmcnt(6)
    s_add_u32 s36, s51, 0x5000
    buffer_load_dwordx4 v[84:87], v1, s[28:31], s36 offen offset:512 nt
    v_dot2c_f32_bf16_dpp v16, v4, v88 row_newbcast:12 row_mask:0xf bank_mask:0xf
    v_dot2c_f32_bf16_dpp v17, v5, v88 row_newbcast:12 row_mask:0xf bank_mask:0xf
    v_dot2c_f32_bf16_dpp v18, v4, v89 row_newbcast:12 row_mask:0xf bank_mask:0xf
    v_dot2c_f32_bf16_dpp v19, v5, v89 row_newbcast:12 row_mask:0xf bank_mask:0xf
    v_dot2c_f32_bf16_dpp v20, v4, v90 row_newbcast:12 row_mask:0xf bank_mask:0xf
    v_dot2c_f32_bf16_dpp v21, v5, v90 row_newbcast:12 row_mask:0xf bank_mask:0xf
    v_dot2c_f32_bf16_dpp v22, v4, v91 row_newbcast:12 row_mask:0xf bank_mask:0xf
    v_dot2c_f32_bf16_dpp v23, v5, v91 row_newbcast:12 row_mask:0xf bank_mask:0xf
    s_waitcnt vmcnt(6)
    s_add_u32 s36, s51, 0x1000
    buffer_load_dwordx4 v[88:91], v1, s[28:31], s36 offen offset:256 nt
    ds_add_u32 v36, v37 offset:6400
    v_dot2c_f32_bf16_dpp v16, v4, v92 row_newbcast:13 row_mask:0xf bank_mask:0xf
    v_dot2c_f32_bf16_dpp v17, v5, v92 row_newbcast:13 row_mask:0xf bank_mask:0xf
    v_dot2c_f32_bf16_dpp v18, v4, v93 row_newbcast:13 row_mask:0xf bank_mask:0xf
    v_dot2c_f32_bf16_dpp v19, v5, v93 row_newbcast:13 row_mask:0xf bank_mask:0xf
    v_dot2c_f32_bf16_dpp v20, v4, v94 row_newbcast:13 row_mask:0xf bank_mask:0xf
    v_dot2c_f32_bf16_dpp v21, v5, v94 row_newbcast:13 row_mask:0xf bank_mask:0xf
    v_dot2c_f32_bf16_dpp v22, v4, v95 row_newbcast:13 row_mask:0xf bank_mask:0xf
    v_dot2c_f32_bf16_dpp v23, v5, v95 row_newbcast:13 row_mask:0xf bank_mask:0xf
    s_waitcnt vmcnt(6)
    s_add_u32 s36, s51, 0x5000
    buffer_load_dwordx4 v[92:95], v1, s[28:31], s36 offen offset:256 nt
    v_dot2c_f32_bf16_dpp v16, v4, v96 row_newbcast:14 row_mask:0xf bank_mask:0xf
    v_dot2c_f32_bf16_dpp v17, v5, v96 row_newbcast:14 row_mask:0xf bank_mask:0xf
    v_dot2c_f32_bf16_dpp v18, v4, v97 row_newbcast:14 row_mask:0xf bank_mask:0xf
    v_dot2c_f32_bf16_dpp v19, v5, v97 row_newbcast:14 row_mask:0xf bank_mask:0xf
    v_dot2c_f32_bf16_dpp v20, v4, v98 row_newbcast:14 row_mask:0xf bank_mask:0xf
    v_dot2c_f32_bf16_dpp v21, v5, v98 row_newbcast:14 row_mask:0xf bank_mask:0xf
    v_dot2c_f32_bf16_dpp v22, v4, v99 row_newbcast:14 row_mask:0xf bank_mask:0xf
    v_dot2c_f32_bf16_dpp v23, v5, v99 row_newbcast:14 row_mask:0xf bank_mask:0xf
    s_waitcnt vmcnt(6)
    s_add_u32 s36, s51, 0x1000
    buffer_load_dwordx4 v[96:99], v1, s[28:31], s36 offen offset:768 nt
    ds_add_u32 v36, v37 offset:6400
    ds_read_b32 v38, v36 offset:7424
    v_dot2c_f32_bf16_dpp v16, v4, v100 row_newbcast:15 row_mask:0xf bank_mask:0xf
    v_dot2c_f32_bf16_dpp v17, v5, v100 row_newbcast:15 row_mask:0xf bank_mask:0xf
    v_dot2c_f32_bf16_dpp v18, v4, v101 row_newbcast:15 row_mask:0xf bank_mask:0xf
    v_dot2c_f32_bf16_dpp v19, v5, v101 row_newbcast:15 row_mask:0xf bank_mask:0xf
    v_dot2c_f32_bf16_dpp v20, v4, v102 row_newbcast:15 row_mask:0xf bank_mask:0xf
    v_dot2c_f32_bf16_dpp v21, v5, v102 row_newbcast:15 row_mask:0xf bank_mask:0xf
    v_dot2c_f32_bf16_dpp v22, v4, v103 row_newbcast:15 row_mask:0xf bank_mask:0xf
    v_dot2c_f32_bf16_dpp v23, v5, v103 row_newbcast:15 row_mask:0xf bank_mask:0xf
    s_waitcnt vmcnt(6)
    s_add_u32 s36, s51, 0x5000
    buffer_load_dwordx4 v[100:103], v1, s[28:31], s36 offen offset:768 nt
    s_waitcnt lgkmcnt(0)
    v_readfirstlane_b32 s48, v38
    s_branch L_vj1
L_k0_0:
    v_dot2_f32_bf16 v16, v40, v4, 0
    v_dot2_f32_bf16 v16, v41, v5, v16
    v_dot2_f32_bf16 v16, v42, v6, v16
    v_dot2_f32_bf16 v16, v43, v7, v16
    s_waitcnt vmcnt(3)
    buffer_load_dwordx4 v[40:43], v1, s[28:31], s51 offen nt
    ds_add_u32 v36, v37 offset:6400
    v_dot2_f32_bf16 v17, v44, v4, 0
    v_dot2_f32_bf16 v17, v45, v5, v17
    v_dot2_f32_bf16 v17, v46, v6, v17
    v_dot2_f32_bf16 v17, v47, v7, v17
    s_waitcnt vmcnt(3)
    s_add_u32 s36, s51, 0x4000
    buffer_load_dwordx4 v[44:47], v1, s[28:31], s36 offen nt
    v_dot2_f32_bf16 v18, v48, v4, 0
    v_dot2_f32_bf16 v18, v49, v5, v18
    v_dot2_f32_bf16 v18, v50, v6, v18
    v_dot2_f32_bf16 v18, v51, v7, v18
    s_waitcnt vmcnt(3)
    buffer_load_dwordx4 v[48:51], v1, s[28:31], s51 offen offset:512 nt
    ds_add_u32 v36, v37 offset:6400
    v_dot2_f32_bf16 v19, v52, v4, 0
    v_dot2_f32_bf16 v19, v53, v5, v19
    v_dot2_f32_bf16 v19, v54, v6, v19
    v_dot2_f32_bf16 v19, v55, v7, v19
    s_waitcnt vmcnt(3)
    buffer_load_dwordx4 v[52:55], v1, s[28:31], s36 offen offset:512 nt
    v_dot2_f32_bf16 v20, v56, v4, 0
    v_dot2_f32_bf16 v20, v57, v5, v20
    v_dot2_f32_bf16 v20, v58, v6, v20
    v_dot2_f32_bf16 v20, v59, v7, v20
    s_waitcnt vmcnt(3)
    buffer_load_dwordx4 v[56:59], v1, s[28:31], s51 offen offset:256 nt
    ds_add_u32 v36, v37 offset:6400
    v_dot2_f32_bf16 v21, v60, v4, 0
    v_dot2_f32_bf16 v21, v61, v5, v21
    v_dot2_f32_bf16 v21, v62, v6, v21
    v_dot2_f32_bf16 v21, v63, v7, v21
    s_waitcnt vmcnt(3)
    buffer_load_dwordx4 v[60:63], v1, s[28:31], s36 offen offset:256 nt
    v_dot2_f32_bf16 v22, v64, v4, 0
    v_dot2_f32_bf16 v22, v65, v5, v22
    v_dot2_f32_bf16 v22, v66, v6, v22
    v_dot2_f32_bf16 v22, v67, v7, v22
    s_waitcnt vmcnt(3)
    buffer_load_dwordx4 v[64:67], v1, s[28:31], s51 offen offset:768 nt
    ds_add_u32 v36, v37 offset:6400
    ds_read_b32 v38, v36 offset:7424
    v_dot2_f32_bf16 v23, v68, v4, 0
    v_dot2_f32_bf16 v23, v69, v5, v23
    v_dot2_f32_bf16 v23, v70, v6, v23
    v_dot2_f32_bf16 v23, v71, v7, v23
    s_waitcnt vmcnt(3)
    buffer_load_dwordx4 v[68:71], v1, s[28:31], s36 offen offset:768 nt
    s_waitcnt lgkmcnt(0)
    v_readfirstlane_b32 s48, v38
    s_branch L_kj0
L_k1_0:
    v_dot2_f32_bf16 v24, v72, v4, 0
    v_dot2_f32_bf16 v24, v73, v5, v24
    v_dot2_f32_bf16 v24, v74, v6, v24
    v_dot2_f32_bf16 v24, v75, v7, v24
    s_waitcnt vmcnt(3)
    s_add_u32 s36, s51, 0x1000
    buffer_load_dwordx4 v[72:75], v1, s[28:31], s36 offen nt
    ds_add_u32 v36, v37 offset:6400
    v_dot2_f32_bf16 v25, v76, v4, 0
    v_dot2_f32_bf16 v25, v77, v5, v25
    v_dot2_f32_bf16 v25, v78, v6, v25
    v_dot2_f32_bf16 v25, v79, v7, v25
    s_waitcnt vmcnt(3)
    s_add_u32 s36, s51, 0x5000
    buffer_load_dwordx4 v[76:79], v1, s[28:31], s36 offen nt
    v_dot2_f32_bf16 v26, v80, v4, 0
    v_dot2_f32_bf16 v26, v81, v5, v26
    v_dot2_f32_bf16 v26, v82, v6, v26
    v_dot2_f32_bf16 v26, v83, v7, v26
    s_waitcnt vmcnt(3)
    s_add_u32 s36, s51, 0x1000
    buffer_load_dwordx4 v[80:83], v1, s[28:31], s36 offen offset:512 nt
    ds_add_u32 v36, v37 offset:6400
    v_dot2_f32_bf16 v27, v84, v4, 0
    v_dot2_f32_bf16 v27, v85, v5, v27
    v_dot2_f32_bf16 v27, v86, v6, v27
    v_dot2_f32_bf16 v27, v87, v7, v27
    s_waitcnt vmcnt(3)
    s_add_u32 s36, s51, 0x5000
    buffer_load_dwordx4 v[84:87], v1, s[28:31], s36 offen offset:512 nt
    v_dot2_f32_bf16 v28, v88, v4, 0
    v_dot2_f32_bf16 v28, v89, v5, v28
    v_dot2_f32_bf16 v28, v90, v6, v28
    v_dot2_f32_bf16 v28, v91, v7, v28
    s_waitcnt vmcnt(3)
    s_add_u32 s36, s51, 0x1000
    buffer_load_dwordx4 v[88:91], v1, s[28:31], s36 offen offset:256 nt
    ds_add_u32 v36, v37 offset:6400
    v_dot2_f32_bf16 v29, v92, v4, 0
    v_dot2_f32_bf16 v29, v93, v5, v29
    v_dot2_f32_bf16 v29, v94, v6, v29
    v_dot2_f32_bf16 v29, v95, v7, v29
    s_waitcnt vmcnt(3)
    s_add_u32 s36, s51, 0x5000
    buffer_load_dwordx4 v[92:95], v1, s[28:31], s36 offen offset:256 nt
    v_dot2_f32_bf16 v30, v96, v4, 0
    v_dot2_f32_bf16 v30, v97, v5, v30
    v_dot2_f32_bf16 v30, v98, v6, v30
    v_dot2_f32_bf16 v30, v99, v7, v30
    s_waitcnt vmcnt(3)
    s_add_u32 s36, s51, 0x1000
    buffer_load_dwordx4 v[96:99], v1, s[28:31], s36 offen offset:768 nt
    ds_add_u32 v36, v37 offset:6400
    ds_read_b32 v38, v36 offset:7424
    v_dot2_f32_bf16 v31, v100, v4, 0
    v_dot2_f32_bf16 v31, v101, v5, v31
    v_dot2_f32_bf16 v31, v102, v6, v31
    v_dot2_f32_bf16 v31, v103, v7, v31
    s_waitcnt vmcnt(3)
    s_add_u32 s36, s51, 0x5000
    buffer_load_dwordx4 v[100:103], v1, s[28:31], s36 offen offset:768 nt
    s_waitcnt lgkmcnt(0)
    v_readfirstlane_b32 s48, v38
    s_branch L_kj1
L_k2_0:
    v_dot2_f32_bf16 v16, v104, v4, 0
    v_dot2_f32_bf16 v16, v105, v5, v16
    v_dot2_f32_bf16 v16, v106, v6, v16
    v_dot2_f32_bf16 v16, v107, v7, v16
    s_waitcnt vmcnt(3)
    s_add_u32 s36, s51, 0x20000
    buffer_load_dwordx4 v[104:107], v1, s[28:31], s36 offen nt
    ds_add_u32 v36, v37 offset:6400
    v_dot2_f32_bf16 v17, v108, v4, 0
    v_dot2_f32_bf16 v17, v109, v5, v17
    v_dot2_f32_bf16 v17, v110, v6, v17
    v_dot2_f32_bf16 v17, v111, v7, v17
    s_waitcnt vmcnt(3)
    s_add_u32 s36, s51, 0x24000
    buffer_load_dwordx4 v[108:111], v1, s[28:31], s36 offen nt
    v_dot2_f32_bf16 v18, v112, v4, 0
    v_dot2_f32_bf16 v18, v113, v5, v18
    v_dot2_f32_bf16 v18, v114, v6, v18
    v_dot2_f32_bf16 v18, v115, v7, v18
    s_waitcnt vmcnt(3)
    s_add_u32 s36, s51, 0x20000
    buffer_load_dwordx4 v[112:115], v1, s[28:31], s36 offen offset:512 nt
    ds_add_u32 v36, v37 offset:6400
    v_dot2_f32_bf16 v19, v116, v4, 0
    v_dot2_f32_bf16 v19, v117, v5, v19
    v_dot2_f32_bf16 v19, v118, v6, v19
    v_dot2_f32_bf16 v19, v119, v7, v19
    s_waitcnt vmcnt(3)
    s_add_u32 s36, s51, 0x24000
    buffer_load_dwordx4 v[116:119], v1, s[28:31], s36 offen offset:512 nt
    v_dot2_f32_bf16 v20, v120, v4, 0
    v_dot2_f32_bf16 v20, v121, v5, v20
    v_dot2_f32_bf16 v20, v122, v6, v20
    v_dot2_f32_bf16 v20, v123, v7, v20
    s_waitcnt vmcnt(3)
    s_add_u32 s36, s51, 0x20000
    buffer_load_dwordx4 v[120:123], v1, s[28:31], s36 offen offset:256 nt
    ds_add_u32 v36, v37 offset:6400
    v_dot2_f32_bf16 v21, v124, v4, 0
    v_dot2_f32_bf16 v21, v125, v5, v21
    v_dot2_f32_bf16 v21, v126, v6, v21
    v_dot2_f32_bf16 v21, v127, v7, v21
    s_waitcnt vmcnt(3)
    s_add_u32 s36, s51, 0x24000
    buffer_load_dwordx4 v[124:127], v1, s[28:31], s36 offen offset:256 nt
    v_dot2_f32_bf16 v22, v128, v4, 0
    v_dot2_f32_bf16 v22, v129, v5, v22
    v_dot2_f32_bf16 v22, v130, v6, v22
    v_dot2_f32_bf16 v22, v131, v7, v22
    s_waitcnt vmcnt(3)
    s_add_u32 s36, s51, 0x20000
    buffer_load_dwordx4 v[128:131], v1, s[28:31], s36 offen offset:768 nt
    ds_add_u32 v36, v37 offset:6400
    ds_read_b32 v38, v36 offset:7424
    v_dot2_f32_bf16 v23, v132, v4, 0
    v_dot2_f32_bf16 v23, v133, v5, v23
    v_dot2_f32_bf16 v23, v134, v6, v23
    v_dot2_f32_bf16 v23, v135, v7, v23
    s_waitcnt vmcnt(3)
    s_add_u32 s36, s51, 0x24000
    buffer_load_dwordx4 v[132:135], v1, s[28:31], s36 offen offset:768 nt
    s_waitcnt lgkmcnt(0)
    v_readfirstlane_b32 s48, v38
    s_branch L_kj2
L_k3_0:
    v_dot2_f32_bf16 v24, v136, v4, 0
    v_dot2_f32_bf16 v24, v137, v5, v24
    v_dot2_f32_bf16 v24, v138, v6, v24
    v_dot2_f32_bf16 v24, v139, v7, v24
    s_waitcnt vmcnt(3)
    s_add_u32 s36, s51, 0x21000
    buffer_load_dwordx4 v[136:139], v1, s[28:31], s36 offen nt
    ds_add_u32 v36, v37 offset:6400
    v_dot2_f32_bf16 v25, v140, v4, 0
    v_dot2_f32_bf16 v25, v141, v5, v25
    v_dot2_f32_bf16 v25, v142, v6, v25
    v_dot2_f32_bf16 v25, v143, v7, v25
    s_waitcnt vmcnt(3)
    s_add_u32 s36, s51, 0x25000
    buffer_load_dwordx4 v[140:143], v1, s[28:31], s36 offen nt
    v_dot2_f32_bf16 v26, v144, v4, 0
    v_dot2_f32_bf16 v26, v145, v5, v26
    v_dot2_f32_bf16 v26, v146, v6, v26
    v_dot2_f32_bf16 v26, v147, v7, v26
    s_waitcnt vmcnt(3)
    s_add_u32 s36, s51, 0x21000
    buffer_load_dwordx4 v[144:147], v1, s[28:31], s36 offen offset:512 nt
    ds_add_u32 v36, v37 offset:6400
    v_dot2_f32_bf16 v27, v148, v4, 0
    v_dot2_f32_bf16 v27, v149, v5, v27
    v_dot2_f32_bf16 v27, v150, v6, v27
    v_dot2_f32_bf16 v27, v151, v7, v27
    s_waitcnt vmcnt(3)
    s_add_u32 s36, s51, 0x25000
    buffer_load_dwordx4 v[148:151], v1, s[28:31], s36 offen offset:512 nt
    v_dot2_f32_bf16 v28, v152, v4, 0
    v_dot2_f32_bf16 v28, v153, v5, v28
    v_dot2_f32_bf16 v28, v154, v6, v28
    v_dot2_f32_bf16 v28, v155, v7, v28
    s_waitcnt vmcnt(3)
    s_add_u32 s36, s51, 0x21000
    buffer_load_dwordx4 v[152:155], v1, s[28:31], s36 offen offset:256 nt
    ds_add_u32 v36, v37 offset:6400
    v_dot2_f32_bf16 v29, v156, v4, 0
    v_dot2_f32_bf16 v29, v157, v5, v29
    v_dot2_f32_bf16 v29, v158, v6, v29
    v_dot2_f32_bf16 v29, v159, v7, v29
    s_waitcnt vmcnt(3)
    s_add_u32 s36, s51, 0x25000
    buffer_load_dwordx4 v[156:159], v1, s[28:31], s36 offen offset:256 nt
    v_dot2_f32_bf16 v30, v160, v4, 0
    v_dot2_f32_bf16 v30, v161, v5, v30
    v_dot2_f32_bf16 v30, v162, v6, v30
    v_dot2_f32_bf16 v30, v163, v7, v30
    s_waitcnt vmcnt(3)
    s_add_u32 s36, s51, 0x21000
    buffer_load_dwordx4 v[160:163], v1, s[28:31], s36 offen offset:768 nt
    ds_add_u32 v36, v37 offset:6400
    ds_read_b32 v38, v36 offset:7424
    v_dot2_f32_bf16 v31, v164, v4, 0
    v_dot2_f32_bf16 v31, v165, v5, v31
    v_dot2_f32_bf16 v31, v166, v6, v31
    v_dot2_f32_bf16 v31, v167, v7, v31
    s_waitcnt vmcnt(3)
    s_add_u32 s36, s51, 0x25000
    buffer_load_dwordx4 v[164:167], v1, s[28:31], s36 offen offset:768 nt
    s_waitcnt lgkmcnt(0)
    v_readfirstlane_b32 s48, v38
    s_branch L_kj3
L_k0_2:
    v_dot2_f32_bf16 v16, v40, v4, 0
    v_dot2_f32_bf16 v16, v41, v5, v16
    v_dot2_f32_bf16 v16, v42, v6, v16
    v_dot2_f32_bf16 v16, v43, v7, v16
    s_waitcnt vmcnt(5)
    buffer_load_dwordx4 v[40:43], v1, s[28:31], s51 offen nt
    ds_add_u32 v36, v37 offset:6400
    v_dot2_f32_bf16 v17, v44, v4, 0
    v_dot2_f32_bf16 v17, v45, v5, v17
    v_dot2_f32_bf16 v17, v46, v6, v17
    v_dot2_f32_bf16 v17, v47, v7, v17
    s_waitcnt vmcnt(5)
    s_add_u32 s36, s51, 0x4000
    buffer_load_dwordx4 v[44:47], v1, s[28:31], s36 offen nt
    v_dot2_f32_bf16 v18, v48, v4, 0
    v_dot2_f32_bf16 v18, v49, v5, v18
    v_dot2_f32_bf16 v18, v50, v6, v18
    v_dot2_f32_bf16 v18, v51, v7, v18
    s_waitcnt vmcnt(5)
    buffer_load_dwordx4 v[48:51], v1, s[28:31], s51 offen offset:512 nt
    ds_add_u32 v36, v37 offset:6400
    v_dot2_f32_bf16 v19, v52, v4, 0
    v_dot2_f32_bf16 v19, v53, v5, v19
    v_dot2_f32_bf16 v19, v54, v6, v19
    v_dot2_f32_bf16 v19, v55, v7, v19
    s_waitcnt vmcnt(5)
    buffer_load_dwordx4 v[52:55], v1, s[28:31], s36 offen offset:512 nt
    v_dot2_f32_bf16 v20, v56, v4, 0
    v_dot2_f32_bf16 v20, v57, v5, v20
    v_dot2_f32_bf16 v20, v58, v6, v20
    v_dot2_f32_bf16 v20, v59, v7, v20
    s_waitcnt vmcnt(5)
    buffer_load_dwordx4 v[56:59], v1, s[28:31], s51 offen offset:256 nt
    ds_add_u32 v36, v37 offset:6400
    v_dot2_f32_bf16 v21, v60, v4, 0
    v_dot2_f32_bf16 v21, v61, v5, v21
    v_dot2_f32_bf16 v21, v62, v6, v21
    v_dot2_f32_bf16 v21, v63, v7, v21
    s_waitcnt vmcnt(5)
    buffer_load_dwordx4 v[60:63], v1, s[28:31], s36 offen offset:256 nt
    v_dot2_f32_bf16 v22, v64, v4, 0
    v_dot2_f32_bf16 v22, v65, v5, v22
    v_dot2_f32_bf16 v22, v66, v6, v22
    v_dot2_f32_bf16 v22, v67, v7, v22
    s_waitcnt vmcnt(5)
    buffer_load_dwordx4 v[64:67], v1, s[28:31], s51 offen offset:768 nt
    ds_add_u32 v36, v37 offset:6400
    ds_read_b32 v38, v36 offset:7424
    v_dot2_f32_bf16 v23, v68, v4, 0
    v_dot2_f32_bf16 v23, v69, v5, v23
    v_dot2_f32_bf16 v23, v70, v6, v23
    v_dot2_f32_bf16 v23, v71, v7, v23
    s_waitcnt vmcnt(5)
    buffer_load_dwordx4 v[68:71], v1, s[28:31], s36 offen offset:768 nt
    s_waitcnt lgkmcnt(0)
    v_readfirstlane_b32 s48, v38
    s_branch L_kj0
L_k1_2:
    v_dot2_f32_bf16 v24, v72, v4, 0
    v_dot2_f32_bf16 v24, v73, v5, v24
    v_dot2_f32_bf16 v24, v74, v6, v24
    v_dot2_f32_bf16 v24, v75, v7, v24
    s_waitcnt vmcnt(5)
    s_add_u32 s36, s51, 0x1000
    buffer_load_dwordx4 v[72:75], v1, s[28:31], s36 offen nt
    ds_add_u32 v36, v37 offset:6400
    v_dot2_f32_bf16 v25, v76, v4, 0
    v_dot2_f32_bf16 v25, v77, v5, v25
    v_dot2_f32_bf16 v25, v78, v6, v25
    v_dot2_f32_bf16 v25, v79, v7, v25
    s_waitcnt vmcnt(5)
    s_add_u32 s36, s51, 0x5000
    buffer_load_dwordx4 v[76:79], v1, s[28:31], s36 offen nt
    v_dot2_f32_bf16 v26, v80, v4, 0
    v_dot2_f32_bf16 v26, v81, v5, v26
    v_dot2_f32_bf16 v26, v82, v6, v26
    v_dot2_f32_bf16 v26, v83, v7, v26
    s_waitcnt vmcnt(5)
    s_add_u32 s36, s51, 0x1000
    buffer_load_dwordx4 v[80:83], v1, s[28:31], s36 offen offset:512 nt
    ds_add_u32 v36, v37 offset:6400
    v_dot2_f32_bf16 v27, v84, v4, 0
    v_dot2_f32_bf16 v27, v85, v5, v27
    v_dot2_f32_bf16 v27, v86, v6, v27
    v_dot2_f32_bf16 v27, v87, v7, v27
    s_waitcnt vmcnt(5)
    s_add_u32 s36, s51, 0x5000
    buffer_load_dwordx4 v[84:87], v1, s[28:31], s36 offen offset:512 nt
    v_dot2_f32_bf16 v28, v88, v4, 0
    v_dot2_f32_bf16 v28, v89, v5, v28
    v_dot2_f32_bf16 v28, v90, v6, v28
    v_dot2_f32_bf16 v28, v91, v7, v28
    s_waitcnt vmcnt(5)
    s_add_u32 s36, s51, 0x1000
    buffer_load_dwordx4 v[88:91], v1, s[28:31], s36 offen offset:256 nt
    ds_add_u32 v36, v37 offset:6400
    v_dot2_f32_bf16 v29, v92, v4, 0
    v_dot2_f32_bf16 v29, v93, v5, v29
    v_dot2_f32_bf16 v29, v94, v6, v29
    v_dot2_f32_bf16 v29, v95, v7, v29
    s_waitcnt vmcnt(5)
    s_add_u32 s36, s51, 0x5000
    buffer_load_dwordx4 v[92:95], v1, s[28:31], s36 offen offset:256 nt
    v_dot2_f32_bf16 v30, v96, v4, 0
    v_dot2_f32_bf16 v30, v97, v5, v30
    v_dot2_f32_bf16 v30, v98, v6, v30
    v_dot2_f32_bf16 v30, v99, v7, v30
    s_waitcnt vmcnt(5)
    s_add_u32 s36, s51, 0x1000
    buffer_load_dwordx4 v[96:99], v1, s[28:31], s36 offen offset:768 nt
    ds_add_u32 v36, v37 offset:6400
    ds_read_b32 v38, v36 offset:7424
    v_dot2_f32_bf16 v31, v100, v4, 0
    v_dot2_f32_bf16 v31, v101, v5, v31
    v_dot2_f32_bf16 v31, v102, v6, v31
    v_dot2_f32_bf16 v31, v103, v7, v31
    s_waitcnt vmcnt(5)
    s_add_u32 s36, s51, 0x5000
    buffer_load_dwordx4 v[100:103], v1, s[28:31], s36 offen offset:768 nt
    s_waitcnt lgkmcnt(0)
    v_readfirstlane_b32 s48, v38
    s_branch L_kj1
L_k2_2:
    v_dot2_f32_bf16 v16, v104, v4, 0
    v_dot2_f32_bf16 v16, v105, v5, v16
    v_dot2_f32_bf16 v16, v106, v6, v16
    v_dot2_f32_bf16 v16, v107, v7, v16
    s_waitcnt vmcnt(5)
    s_add_u32 s36, s51, 0x20000
    buffer_load_dwordx4 v[104:107], v1, s[28:31], s36 offen nt
    ds_add_u32 v36, v37 offset:6400
    v_dot2_f32_bf16 v17, v108, v4, 0
    v_dot2_f32_bf16 v17, v109, v5, v17
    v_dot2_f32_bf16 v17, v110, v6, v17
    v_dot2_f32_bf16 v17, v111, v7, v17
    s_waitcnt vmcnt(5)
    s_add_u32 s36, s51, 0x24000
    buffer_load_dwordx4 v[108:111], v1, s[28:31], s36 offen nt
    v_dot2_f32_bf16 v18, v112, v4, 0
    v_dot2_f32_bf16 v18, v113, v5, v18
    v_dot2_f32_bf16 v18, v114, v6, v18
    v_dot2_f32_bf16 v18, v115, v7, v18
    s_waitcnt vmcnt(5)
    s_add_u32 s36, s51, 0x20000
    buffer_load_dwordx4 v[112:115], v1, s[28:31], s36 offen offset:512 nt
    ds_add_u32 v36, v37 offset:6400
    v_dot2_f32_bf16 v19, v116, v4, 0
    v_dot2_f32_bf16 v19, v117, v5, v19
    v_dot2_f32_bf16 v19, v118, v6, v19
    v_dot2_f32_bf16 v19, v119, v7, v19
    s_waitcnt vmcnt(5)
    s_add_u32 s36, s51, 0x24000
    buffer_load_dwordx4 v[116:119], v1, s[28:31], s36 offen offset:512 nt
    v_dot2_f32_bf16 v20, v120, v4, 0
    v_dot2_f32_bf16 v20, v121, v5, v20
    v_dot2_f32_bf16 v20, v122, v6, v20
    v_dot2_f32_bf16 v20, v123, v7, v20
    s_waitcnt vmcnt(5)
    s_add_u32 s36, s51, 0x20000
    buffer_load_dwordx4 v[120:123], v1, s[28:31], s36 offen offset:256 nt
    ds_add_u32 v36, v37 offset:6400
    v_dot2_f32_bf16 v21, v124, v4, 0
    v_dot2_f32_bf16 v21, v125, v5, v21
    v_dot2_f32_bf16 v21, v126, v6, v21
    v_dot2_f32_bf16 v21, v127, v7, v21
    s_waitcnt vmcnt(5)
    s_add_u32 s36, s51, 0x24000
    buffer_load_dwordx4 v[124:127], v1, s[28:31], s36 offen offset:256 nt
    v_dot2_f32_bf16 v22, v128, v4, 0
    v_dot2_f32_bf16 v22, v129, v5, v22
    v_dot2_f32_bf16 v22, v130, v6, v22
    v_dot2_f32_bf16 v22, v131, v7, v22
    s_waitcnt vmcnt(5)
    s_add_u32 s36, s51, 0x20000
    buffer_load_dwordx4 v[128:131], v1, s[28:31], s36 offen offset:768 nt
    ds_add_u32 v36, v37 offset:6400
    ds_read_b32 v38, v36 offset:7424
    v_dot2_f32_bf16 v23, v132, v4, 0
    v_dot2_f32_bf16 v23, v133, v5, v23
    v_dot2_f32_bf16 v23, v134, v6, v23
    v_dot2_f32_bf16 v23, v135, v7, v23
    s_waitcnt vmcnt(5)
    s_add_u32 s36, s51, 0x24000
    buffer_load_dwordx4 v[132:135], v1, s[28:31], s36 offen offset:768 nt
    s_waitcnt lgkmcnt(0)
    v_readfirstlane_b32 s48, v38
    s_branch L_kj2
L_k3_2:
    v_dot2_f32_bf16 v24, v136, v4, 0
    v_dot2_f32_bf16 v24, v137, v5, v24
    v_dot2_f32_bf16 v24, v138, v6, v24
    v_dot2_f32_bf16 v24, v139, v7, v24
    s_waitcnt vmcnt(5)
    s_add_u32 s36, s51, 0x21000
    buffer_load_dwordx4 v[136:139], v1, s[28:31], s36 offen nt
    ds_add_u32 v36, v37 offset:6400
    v_dot2_f32_bf16 v25, v140, v4, 0
    v_dot2_f32_bf16 v25, v141, v5, v25
    v_dot2_f32_bf16 v25, v142, v6, v25
    v_dot2_f32_bf16 v25, v143, v7, v25
    s_waitcnt vmcnt(5)
    s_add_u32 s36, s51, 0x25000
    buffer_load_dwordx4 v[140:143], v1, s[28:31], s36 offen nt
    v_dot2_f32_bf16 v26, v144, v4, 0
    v_dot2_f32_bf16 v26, v145, v5, v26
    v_dot2_f32_bf16 v26, v146, v6, v26
    v_dot2_f32_bf16 v26, v147, v7, v26
    s_waitcnt vmcnt(5)
    s_add_u32 s36, s51, 0x21000
    buffer_load_dwordx4 v[144:147], v1, s[28:31], s36 offen offset:512 nt
    ds_add_u32 v36, v37 offset:6400
    v_dot2_f32_bf16 v27, v148, v4, 0
    v_dot2_f32_bf16 v27, v149, v5, v27
    v_dot2_f32_bf16 v27, v150, v6, v27
    v_dot2_f32_bf16 v27, v151, v7, v27
    s_waitcnt vmcnt(5)
    s_add_u32 s36, s51, 0x25000
    buffer_load_dwordx4 v[148:151], v1, s[28:31], s36 offen offset:512 nt
    v_dot2_f32_bf16 v28, v152, v4, 0
    v_dot2_f32_bf16 v28, v153, v5, v28
    v_dot2_f32_bf16 v28, v154, v6, v28
    v_dot2_f32_bf16 v28, v155, v7, v28
    s_waitcnt vmcnt(5)
    s_add_u32 s36, s51, 0x21000
    buffer_load_dwordx4 v[152:155], v1, s[28:31], s36 offen offset:256 nt
    ds_add_u32 v36, v37 offset:6400
    v_dot2_f32_bf16 v29, v156, v4, 0
    v_dot2_f32_bf16 v29, v157, v5, v29
    v_dot2_f32_bf16 v29, v158, v6, v29
    v_dot2_f32_bf16 v29, v159, v7, v29
    s_waitcnt vmcnt(5)
    s_add_u32 s36, s51, 0x25000
    buffer_load_dwordx4 v[156:159], v1, s[28:31], s36 offen offset:256 nt
    v_dot2_f32_bf16 v30, v160, v4, 0
    v_dot2_f32_bf16 v30, v161, v5, v30
    v_dot2_f32_bf16 v30, v162, v6, v30
    v_dot2_f32_bf16 v30, v163, v7, v30
    s_waitcnt vmcnt(5)
    s_add_u32 s36, s51, 0x21000
    buffer_load_dwordx4 v[160:163], v1, s[28:31], s36 offen offset:768 nt
    ds_add_u32 v36, v37 offset:6400
    ds_read_b32 v38, v36 offset:7424
    v_dot2_f32_bf16 v31, v164, v4, 0
    v_dot2_f32_bf16 v31, v165, v5, v31
    v_dot2_f32_bf16 v31, v166, v6, v31
    v_dot2_f32_bf16 v31, v167, v7, v31
    s_waitcnt vmcnt(5)
    s_add_u32 s36, s51, 0x25000
    buffer_load_dwordx4 v[164:167], v1, s[28:31], s36 offen offset:768 nt
    s_waitcnt lgkmcnt(0)
    v_readfirstlane_b32 s48, v38
    s_branch L_kj3
L_k0_3:
    v_dot2_f32_bf16 v16, v40, v4, 0
    v_dot2_f32_bf16 v16, v41, v5, v16
    v_dot2_f32_bf16 v16, v42, v6, v16
    v_dot2_f32_bf16 v16, v43, v7, v16
    s_waitcnt vmcnt(6)
    buffer_load_dwordx4 v[40:43], v1, s[28:31], s51 offen nt
    ds_add_u32 v36, v37 offset:6400
    v_dot2_f32_bf16 v17, v44, v4, 0
    v_dot2_f32_bf16 v17, v45, v5, v17
    v_dot2_f32_bf16 v17, v46, v6, v17
    v_dot2_f32_bf16 v17, v47, v7, v17
    s_waitcnt vmcnt(6)
    s_add_u32 s36, s51, 0x4000
    buffer_load_dwordx4 v[44:47], v1, s[28:31], s36 offen nt
    v_dot2_f32_bf16 v18, v48, v4, 0
    v_dot2_f32_bf16 v18, v49, v5, v18
    v_dot2_f32_bf16 v18, v50, v6, v18
    v_dot2_f32_bf16 v18, v51, v7, v18
    s_waitcnt vmcnt(6)
    buffer_load_dwordx4 v[48:51], v1, s[28:31], s51 offen offset:512 nt
    ds_add_u32 v36, v37 offset:6400
    v_dot2_f32_bf16 v19, v52, v4, 0
    v_dot2_f32_bf16 v19, v53, v5, v19
    v_dot2_f32_bf16 v19, v54, v6, v19
    v_dot2_f32_bf16 v19, v55, v7, v19
    s_waitcnt vmcnt(6)
    buffer_load_dwordx4 v[52:55], v1, s[28:31], s36 offen offset:512 nt
    v_dot2_f32_bf16 v20, v56, v4, 0
    v_dot2_f32_bf16 v20, v57, v5, v20
    v_dot2_f32_bf16 v20, v58, v6, v20
    v_dot2_f32_bf16 v20, v59, v7, v20
    s_waitcnt vmcnt(6)
    buffer_load_dwordx4 v[56:59], v1, s[28:31], s51 offen offset:256 nt
    ds_add_u32 v36, v37 offset:6400
    v_dot2_f32_bf16 v21, v60, v4, 0
    v_dot2_f32_bf16 v21, v61, v5, v21
    v_dot2_f32_bf16 v21, v62, v6, v21
    v_dot2_f32_bf16 v21, v63, v7, v21
    s_waitcnt vmcnt(6)
    buffer_load_dwordx4 v[60:63], v1, s[28:31], s36 offen offset:256 nt
    v_dot2_f32_bf16 v22, v64, v4, 0
    v_dot2_f32_bf16 v22, v65, v5, v22
    v_dot2_f32_bf16 v22, v66, v6, v22
    v_dot2_f32_bf16 v22, v67, v7, v22
    s_waitcnt vmcnt(6)
    buffer_load_dwordx4 v[64:67], v1, s[28:31], s51 offen offset:768 nt
    ds_add_u32 v36, v37 offset:6400
    ds_read_b32 v38, v36 offset:7424
    v_dot2_f32_bf16 v23, v68, v4, 0
    v_dot2_f32_bf16 v23, v69, v5, v23
    v_dot2_f32_bf16 v23, v70, v6, v23
    v_dot2_f32_bf16 v23, v71, v7, v23
    s_waitcnt vmcnt(6)
    buffer_load_dwordx4 v[68:71], v1, s[28:31], s36 offen offset:768 nt
    s_waitcnt lgkmcnt(0)
    v_readfirstlane_b32 s48, v38
    s_branch L_kj0
L_k1_3:
    v_dot2_f32_bf16 v24, v72, v4, 0
    v_dot2_f32_bf16 v24, v73, v5, v24
    v_dot2_f32_bf16 v24, v74, v6, v24
    v_dot2_f32_bf16 v24, v75, v7, v24
    s_waitcnt vmcnt(6)
    s_add_u32 s36, s51, 0x1000
    buffer_load_dwordx4 v[72:75], v1, s[28:31], s36 offen nt
    ds_add_u32 v36, v37 offset:6400
    v_dot2_f32_bf16 v25, v76, v4, 0
    v_dot2_f32_bf16 v25, v77, v5, v25
    v_dot2_f32_bf16 v25, v78, v6, v25
    v_dot2_f32_bf16 v25, v79, v7, v25
    s_waitcnt vmcnt(6)
    s_add_u32 s36, s51, 0x5000
    buffer_load_dwordx4 v[76:79], v1, s[28:31], s36 offen nt
    v_dot2_f32_bf16 v26, v80, v4, 0
    v_dot2_f32_bf16 v26, v81, v5, v26
    v_dot2_f32_bf16 v26, v82, v6, v26
    v_dot2_f32_bf16 v26, v83, v7, v26
    s_waitcnt vmcnt(6)
    s_add_u32 s36, s51, 0x1000
    buffer_load_dwordx4 v[80:83], v1, s[28:31], s36 offen offset:512 nt
    ds_add_u32 v36, v37 offset:6400
    v_dot2_f32_bf16 v27, v84, v4, 0
    v_dot2_f32_bf16 v27, v85, v5, v27
    v_dot2_f32_bf16 v27, v86, v6, v27
    v_dot2_f32_bf16 v27, v87, v7, v27
    s_waitcnt vmcnt(6)
    s_add_u32 s36, s51, 0x5000
    buffer_load_dwordx4 v[84:87], v1, s[28:31], s36 offen offset:512 nt
    v_dot2_f32_bf16 v28, v88, v4, 0
    v_dot2_f32_bf16 v28, v89, v5, v28
    v_dot2_f32_bf16 v28, v90, v6, v28
    v_dot2_f32_bf16 v28, v91, v7, v28
    s_waitcnt vmcnt(6)
    s_add_u32 s36, s51, 0x1000
    buffer_load_dwordx4 v[88:91], v1, s[28:31], s36 offen offset:256 nt
    ds_add_u32 v36, v37 offset:6400
    v_dot2_f32_bf16 v29, v92, v4, 0
    v_dot2_f32_bf16 v29, v93, v5, v29
    v_dot2_f32_bf16 v29, v94, v6, v29
    v_dot2_f32_bf16 v29, v95, v7, v29
    s_waitcnt vmcnt(6)
    s_add_u32 s36, s51, 0x5000
    buffer_load_dwordx4 v[92:95], v1, s[28:31], s36 offen offset:256 nt
    v_dot2_f32_bf16 v30, v96, v4, 0
    v_dot2_f32_bf16 v30, v97, v5, v30
    v_dot2_f32_bf16 v30, v98, v6, v30
    v_dot2_f32_bf16 v30, v99, v7, v30
    s_waitcnt vmcnt(6)
    s_add_u32 s36, s51, 0x1000
    buffer_load_dwordx4 v[96:99], v1, s[28:31], s36 offen offset:768 nt
    ds_add_u32 v36, v37 offset:6400
    ds_read_b32 v38, v36 offset:7424
    v_dot2_f32_bf16 v31, v100, v4, 0
    v_dot2_f32_bf16 v31, v101, v5, v31
    v_dot2_f32_bf16 v31, v102, v6, v31
    v_dot2_f32_bf16 v31, v103, v7, v31
    s_waitcnt vmcnt(6)
    s_add_u32 s36, s51, 0x5000
    buffer_load_dwordx4 v[100:103], v1, s[28:31], s36 offen offset:768 nt
    s_waitcnt lgkmcnt(0)
    v_readfirstlane_b32 s48, v38
    s_branch L_kj1
L_k2_3:
    v_dot2_f32_bf16 v16, v104, v4, 0
    v_dot2_f32_bf16 v16, v105, v5, v16
    v_dot2_f32_bf16 v16, v106, v6, v16
    v_dot2_f32_bf16 v16, v107, v7, v16
    s_waitcnt vmcnt(6)
    s_add_u32 s36, s51, 0x20000
    buffer_load_dwordx4 v[104:107], v1, s[28:31], s36 offen nt
    ds_add_u32 v36, v37 offset:6400
    v_dot2_f32_bf16 v17, v108, v4, 0
    v_dot2_f32_bf16 v17, v109, v5, v17
    v_dot2_f32_bf16 v17, v110, v6, v17
    v_dot2_f32_bf16 v17, v111, v7, v17
    s_waitcnt vmcnt(6)
    s_add_u32 s36, s51, 0x24000
    buffer_load_dwordx4 v[108:111], v1, s[28:31], s36 offen nt
    v_dot2_f32_bf16 v18, v112, v4, 0
    v_dot2_f32_bf16 v18, v113, v5, v18
    v_dot2_f32_bf16 v18, v114, v6, v18
    v_dot2_f32_bf16 v18, v115, v7, v18
    s_waitcnt vmcnt(6)
    s_add_u32 s36, s51, 0x20000
    buffer_load_dwordx4 v[112:115], v1, s[28:31], s36 offen offset:512 nt
    ds_add_u32 v36, v37 offset:6400
    v_dot2_f32_bf16 v19, v116, v4, 0
    v_dot2_f32_bf16 v19, v117, v5, v19
    v_dot2_f32_bf16 v19, v118, v6, v19
    v_dot2_f32_bf16 v19, v119, v7, v19
    s_waitcnt vmcnt(6)
    s_add_u32 s36, s51, 0x24000
    buffer_load_dwordx4 v[116:119], v1, s[28:31], s36 offen offset:512 nt
    v_dot2_f32_bf16 v20, v120, v4, 0
    v_dot2_f32_bf16 v20, v121, v5, v20
    v_dot2_f32_bf16 v20, v122, v6, v20
    v_dot2_f32_bf16 v20, v123, v7, v20
    s_waitcnt vmcnt(6)
    s_add_u32 s36, s51, 0x20000
    buffer_load_dwordx4 v[120:123], v1, s[28:31], s36 offen offset:256 nt
    ds_add_u32 v36, v37 offset:6400
    v_dot2_f32_bf16 v21, v124, v4, 0
    v_dot2_f32_bf16 v21, v125, v5, v21
    v_dot2_f32_bf16 v21, v126, v6, v21
    v_dot2_f32_bf16 v21, v127, v7, v21
    s_waitcnt vmcnt(6)
    s_add_u32 s36, s51, 0x24000
    buffer_load_dwordx4 v[124:127], v1, s[28:31], s36 offen offset:256 nt
    v_dot2_f32_bf16 v22, v128, v4, 0
    v_dot2_f32_bf16 v22, v129, v5, v22
    v_dot2_f32_bf16 v22, v130, v6, v22
    v_dot2_f32_bf16 v22, v131, v7, v22
    s_waitcnt vmcnt(6)
    s_add_u32 s36, s51, 0x20000
    buffer_load_dwordx4 v[128:131], v1, s[28:31], s36 offen offset:768 nt
    ds_add_u32 v36, v37 offset:6400
    ds_read_b32 v38, v36 offset:7424
    v_dot2_f32_bf16 v23, v132, v4, 0
    v_dot2_f32_bf16 v23, v133, v5, v23
    v_dot2_f32_bf16 v23, v134, v6, v23
    v_dot2_f32_bf16 v23, v135, v7, v23
    s_waitcnt vmcnt(6)
    s_add_u32 s36, s51, 0x24000
    buffer_load_dwordx4 v[132:135], v1, s[28:31], s36 offen offset:768 nt
    s_waitcnt lgkmcnt(0)
    v_readfirstlane_b32 s48, v38
    s_branch L_kj2
L_k3_3:
    v_dot2_f32_bf16 v24, v136, v4, 0
    v_dot2_f32_bf16 v24, v137, v5, v24
    v_dot2_f32_bf16 v24, v138, v6, v24
    v_dot2_f32_bf16 v24, v139, v7, v24
    s_waitcnt vmcnt(6)
    s_add_u32 s36, s51, 0x21000
    buffer_load_dwordx4 v[136:139], v1, s[28:31], s36 offen nt
    ds_add_u32 v36, v37 offset:6400
    v_dot2_f32_bf16 v25, v140, v4, 0
    v_dot2_f32_bf16 v25, v141, v5, v25
    v_dot2_f32_bf16 v25, v142, v6, v25
    v_dot2_f32_bf16 v25, v143, v7, v25
    s_waitcnt vmcnt(6)
    s_add_u32 s36, s51, 0x25000
    buffer_load_dwordx4 v[140:143], v1, s[28:31], s36 offen nt
    v_dot2_f32_bf16 v26, v144, v4, 0
    v_dot2_f32_bf16 v26, v145, v5, v26
    v_dot2_f32_bf16 v26, v146, v6, v26
    v_dot2_f32_bf16 v26, v147, v7, v26
    s_waitcnt vmcnt(6)
    s_add_u32 s36, s51, 0x21000
    buffer_load_dwordx4 v[144:147], v1, s[28:31], s36 offen offset:512 nt
    ds_add_u32 v36, v37 offset:6400
    v_dot2_f32_bf16 v27, v148, v4, 0
    v_dot2_f32_bf16 v27, v149, v5, v27
    v_dot2_f32_bf16 v27, v150, v6, v27
    v_dot2_f32_bf16 v27, v151, v7, v27
    s_waitcnt vmcnt(6)
    s_add_u32 s36, s51, 0x25000
    buffer_load_dwordx4 v[148:151], v1, s[28:31], s36 offen offset:512 nt
    v_dot2_f32_bf16 v28, v152, v4, 0
    v_dot2_f32_bf16 v28, v153, v5, v28
    v_dot2_f32_bf16 v28, v154, v6, v28
    v_dot2_f32_bf16 v28, v155, v7, v28
    s_waitcnt vmcnt(6)
    s_add_u32 s36, s51, 0x21000
    buffer_load_dwordx4 v[152:155], v1, s[28:31], s36 offen offset:256 nt
    ds_add_u32 v36, v37 offset:6400
    v_dot2_f32_bf16 v29, v156, v4, 0
    v_dot2_f32_bf16 v29, v157, v5, v29
    v_dot2_f32_bf16 v29, v158, v6, v29
    v_dot2_f32_bf16 v29, v159, v7, v29
    s_waitcnt vmcnt(6)
    s_add_u32 s36, s51, 0x25000
    buffer_load_dwordx4 v[156:159], v1, s[28:31], s36 offen offset:256 nt
    v_dot2_f32_bf16 v30, v160, v4, 0
    v_dot2_f32_bf16 v30, v161, v5, v30
    v_dot2_f32_bf16 v30, v162, v6, v30
    v_dot2_f32_bf16 v30, v163, v7, v30
    s_waitcnt vmcnt(6)
    s_add_u32 s36, s51, 0x21000
    buffer_load_dwordx4 v[160:163], v1, s[28:31], s36 offen offset:768 nt
    ds_add_u32 v36, v37 offset:6400
    ds_read_b32 v38, v36 offset:7424
    v_dot2_f32_bf16 v31, v164, v4, 0
    v_dot2_f32_bf16 v31, v165, v5, v31
    v_dot2_f32_bf16 v31, v166, v6, v31
    v_dot2_f32_bf16 v31, v167, v7, v31
    s_waitcnt vmcnt(6)
    s_add_u32 s36, s51, 0x25000
    buffer_load_dwordx4 v[164:167], v1, s[28:31], s36 offen offset:768 nt
    s_waitcnt lgkmcnt(0)
    v_readfirstlane_b32 s48, v38
    s_branch L_kj3
L_codeend:
.section .rodata,"a"
.p2align 6
.amdhsa_kernel parallel_sum__mha_block_cached__dense_activation_silu__decode_kernel
  .amdhsa_next_free_vgpr 168
  .amdhsa_next_free_sgpr 102
  .amdhsa_accum_offset 168
  .amdhsa_group_segment_fixed_size 0
  .amdhsa_kernarg_size 88
  .amdhsa_user_sgpr_count 2
  .amdhsa_user_sgpr_kernarg_segment_ptr 1
  .amdhsa_system_sgpr_workgroup_id_x 1
  .amdhsa_float_denorm_mode_32 3
.end_amdhsa_kernel
```
